```python
import torch

def _softmax(x, axis=-1):
    return torch.softmax(x, dim=axis)
def _gelu(x):
    return torch.nn.functional.gelu(x, approximate="tanh")
def _silu(x):
    return torch.nn.functional.silu(x)
def _sigmoid(x):
    return torch.sigmoid(x)
def _layernorm(x, axis=-1, eps=1e-5):
    m = x.mean(dim=axis, keepdim=True)
    v = x.var(dim=axis, keepdim=True, unbiased=False)
    return (x - m) / torch.sqrt(v + eps)
def _scatter_add(tgt, idx, src, axis=0):
    return tgt.clone().index_add_(axis, idx, src)
def _segment_sum(src, seg, n):
    out = torch.zeros((n,) + src.shape[1:], dtype=src.dtype)
    return out.index_add_(0, seg, src)
def _pad(x, pw):
    flat = tuple(v for pair in reversed(pw) for v in pair)
    return torch.nn.functional.pad(x, flat)

kernel_name = 'gated_mix__spectral_gfnet__glu_gated_geglu__prompt'

def setup_inputs():

    _w = (lambda a: (lambda t: t.to(torch.bfloat16) if t.is_floating_point() else t)(torch.as_tensor(a)))
    def _A_setup():
        B, S, D = 1, 2048, 448
        Df = D // 2 + 1
        return {
            "x": _w((lambda *s: torch.randn(*s, dtype=torch.bfloat16) * 0.05)(B, S, D)),
            "w_r": _w((lambda *s: torch.randn(*s, dtype=torch.bfloat16) * 0.05)(S, Df) * 0.02),
            "w_i": _w((lambda *s: torch.randn(*s, dtype=torch.bfloat16) * 0.05)(S, Df) * 0.02),
        }
    _A_in = _A_setup()

    def _B_setup():
        B, S, Dm, Df = 1, 2048, 448, 1792
        return {
            "x": _w((lambda *s: torch.randn(*s, dtype=torch.bfloat16) * 0.05)(B, S, Dm)),
            "w_gate": _w((lambda *s: torch.randn(*s, dtype=torch.bfloat16) * 0.2)(Dm, Df) * (Dm ** -0.5)),
            "w_up": _w((lambda *s: torch.randn(*s, dtype=torch.bfloat16) * 0.2)(Dm, Df) * (Dm ** -0.5)),
            "w_down": _w((lambda *s: torch.randn(*s, dtype=torch.bfloat16) * 0.2)(Df, Dm) * (Df ** -0.5)),
        }
    _B_in = _B_setup()

    return {
        "A_x": _A_in["x"],
        "A_w_r": _A_in["w_r"],
        "A_w_i": _A_in["w_i"],
        "B_x": _B_in["x"],
        "B_w_gate": _B_in["w_gate"],
        "B_w_up": _B_in["w_up"],
        "B_w_down": _B_in["w_down"],
        "gate_w": _w((lambda *s: torch.randn(*s, dtype=torch.bfloat16) * 0.05)(448) * 16.0),
    }

def reference(A_x, A_w_r, A_w_i, B_x, B_w_gate, B_w_up, B_w_down, gate_w):
    def _A_ref(x, w_r, w_i):
        B, S, D = x.shape
        X = (lambda x, axes=(-2,-1): torch.fft.rfft2(x.float(), dim=axes))(x, axes=(-2, -1))
        W = w_r + 1j * w_i
        X = X * W
        y = (lambda x, s, axes=(-2,-1): torch.fft.irfft2(x, s=s, dim=axes).to(torch.bfloat16))(X, (S, D), axes=(-2, -1))
        return y

    def _B_ref(x, w_gate, w_up, w_down):
        g = torch.einsum("bsd,df->bsf", x, w_gate)
        u = torch.einsum("bsd,df->bsf", x, w_up)
        h = _gelu(g) * u
        return torch.einsum("bsf,fd->bsd", h, w_down)

    x = A_x
    g = _sigmoid((x * gate_w).sum(-1, keepdims=True))
    a = _A_ref(x, A_w_r, A_w_i)
    b = _B_ref(x, B_w_gate, B_w_up, B_w_down)
    return g * a + (1 - g) * b
```

```asm
; @launch kernel=k1_gateup_dft_kernel grid=(256,1,1) block=(512,1,1) lds=147456
; @launch kernel=k2_down_fft_kernel grid=(225,1,1) block=(512,1,1) lds=147456
.amdgcn_target "amdgcn-amd-amdhsa--gfx950"
.text
.globl k1_gateup_dft_kernel
.p2align 8
.type k1_gateup_dft_kernel,@function
k1_gateup_dft_kernel:
    s_cmp_ge_u32 s2, 256
    s_cbranch_scc1 K1_END
    s_load_dwordx2 s[4:5], s[0:1], 0
    s_load_dwordx4 s[60:63], s[0:1], 8
    s_load_dwordx4 s[64:67], s[0:1], 32
    s_load_dwordx2 s[68:69], s[0:1], 56
    s_load_dwordx2 s[70:71], s[0:1], 80
    s_load_dwordx2 s[6:7], s[0:1], 48
    v_and_b32 v1, 63, v0
    v_lshrrev_b32 v2, 6, v0
    s_nop 0
    v_readfirstlane_b32 s36, v2
    s_waitcnt lgkmcnt(0)
    s_mov_b32 s8, s4
    s_mov_b32 s9, s5
    s_mov_b32 s10, 1835008
    s_mov_b32 s11, 0x00020000
    s_mov_b32 s24, s60
    s_mov_b32 s25, s61
    s_mov_b32 s26, 921600
    s_mov_b32 s27, 0x00020000
    s_mov_b32 s28, s62
    s_mov_b32 s29, s63
    s_mov_b32 s30, 921600
    s_mov_b32 s31, 0x00020000
    s_mov_b32 s12, s64
    s_mov_b32 s13, s65
    s_mov_b32 s14, 1605632
    s_mov_b32 s15, 0x00020000
    s_mov_b32 s16, s66
    s_mov_b32 s17, s67
    s_mov_b32 s18, 1605632
    s_mov_b32 s19, 0x00020000
    s_mov_b32 s32, s68
    s_mov_b32 s33, s69
    s_mov_b32 s34, 896
    s_mov_b32 s35, 0x00020000
    s_mov_b32 s20, s70
    s_mov_b32 s21, s71
    s_mov_b32 s22, 17825792
    s_mov_b32 s23, 0x00020000
    s_mov_b32 s64, s6
    s_mov_b32 s65, s7
    s_mov_b32 s66, 1605632
    s_mov_b32 s67, 0x00020000
    s_cmp_ge_u32 s2, 224
    s_cbranch_scc1 K1_DFT
    s_and_b32 s72, s2, 7
    s_lshr_b32 s73, s2, 3
    s_and_b32 s74, s72, 1
    s_lshl_b32 s74, s74, 2
    s_and_b32 s75, s73, 3
    s_add_u32 s74, s74, s75
    s_lshr_b32 s75, s72, 1
    s_mul_i32 s75, s75, 7
    s_lshr_b32 s76, s73, 2
    s_add_u32 s75, s75, s76
    s_lshl_b32 s76, s74, 3
    s_add_u32 s76, s76, s36
    s_mul_i32 s76, s76, 896
    v_lshrrev_b32 v8, 3, v1
    v_mul_u32_u24 v9, 57344, v8
    v_add_u32 v9, s76, v9
    v_lshrrev_b32 v10, 4, v1
    v_and_b32 v11, 7, v1
    v_xor_b32 v12, v11, v10
    v_xor_b32 v13, 4, v12
    v_lshl_add_u32 v4, v12, 4, v9
    v_lshl_add_u32 v5, v13, 4, v9
    v_add_u32 v5, 458752, v5
    v_add_u32 v6, 917504, v4
    v_add_u32 v7, 917504, v5
    s_lshl_b32 s77, s36, 3
    v_add_u32 v9, s77, v8
    v_mul_u32_u24 v9, 3584, v9
    v_and_b32 v10, 1, v10
    v_lshlrev_b32 v10, 2, v10
    v_xor_b32 v10, v11, v10
    v_lshl_add_u32 v3, v10, 4, v9
    s_lshl_b32 s77, s75, 7
    v_add_u32 v3, s77, v3
    s_lshl_b32 s78, s36, 12
    s_lshl_b32 s79, s36, 10
    s_mov_b32 s81, 0
    s_add_u32 m0, s79, 32768
    s_nop 0
    buffer_load_dwordx4 v3, s[12:15], s81 offen lds
    s_add_u32 m0, s79, 40960
    s_nop 0
    buffer_load_dwordx4 v3, s[16:19], s81 offen lds
    s_mov_b32 s80, 0
    s_add_u32 m0, s78, 0
    s_nop 0
    buffer_load_dwordx4 v4, s[8:11], s80 offen lds
    s_add_u32 m0, s78, 1024
    s_nop 0
    buffer_load_dwordx4 v5, s[8:11], s80 offen lds
    s_mov_b32 s80, 0
    s_add_u32 m0, s78, 2048
    s_nop 0
    buffer_load_dwordx4 v6, s[8:11], s80 offen lds
    s_add_u32 m0, s78, 3072
    s_nop 0
    buffer_load_dwordx4 v7, s[8:11], s80 offen lds
    s_lshr_b32 s82, s36, 1
    s_and_b32 s83, s36, 1
    s_lshl_b32 s84, s82, 13
    v_and_b32 v8, 31, v1
    v_lshlrev_b32 v8, 7, v8
    v_add_u32 v8, s84, v8
    v_lshrrev_b32 v9, 5, v1
    v_lshrrev_b32 v10, 1, v1
    v_and_b32 v10, 7, v10
    v_add_u32 v11, 0, v9
    v_xor_b32 v11, v11, v10
    v_lshl_add_u32 v14, v11, 4, v8
    v_add_u32 v18, 49152, v14
    v_add_u32 v22, 98304, v14
    v_add_u32 v11, 2, v9
    v_xor_b32 v11, v11, v10
    v_lshl_add_u32 v15, v11, 4, v8
    v_add_u32 v19, 49152, v15
    v_add_u32 v23, 98304, v15
    v_add_u32 v11, 4, v9
    v_xor_b32 v11, v11, v10
    v_lshl_add_u32 v16, v11, 4, v8
    v_add_u32 v20, 49152, v16
    v_add_u32 v24, 98304, v16
    v_add_u32 v11, 6, v9
    v_xor_b32 v11, v11, v10
    v_lshl_add_u32 v17, v11, 4, v8
    v_add_u32 v21, 49152, v17
    v_add_u32 v25, 98304, v17
    v_and_b32 v8, 15, v1
    v_lshrrev_b32 v9, 2, v8
    v_lshrrev_b32 v10, 5, v1
    v_lshl_add_u32 v9, v10, 3, v9
    v_lshlrev_b32 v9, 7, v9
    v_lshrrev_b32 v10, 4, v1
    v_and_b32 v10, 1, v10
    v_lshlrev_b32 v10, 1, v10
    v_lshrrev_b32 v11, 1, v8
    v_and_b32 v11, 1, v11
    v_add_u32 v10, v10, v11
    s_lshl_b32 s84, s83, 2
    v_add_u32 v10, s84, v10
    v_lshrrev_b32 v11, 3, v8
    v_lshlrev_b32 v11, 2, v11
    v_xor_b32 v10, v10, v11
    v_lshl_add_u32 v9, v10, 4, v9
    v_and_b32 v11, 1, v8
    v_lshl_add_u32 v26, v11, 3, v9
    v_add_u32 v27, 49152, v26
    v_add_u32 v28, 98304, v26
    s_mov_b32 s81, 229376
    s_add_u32 m0, s79, 81920
    s_nop 0
    buffer_load_dwordx4 v3, s[12:15], s81 offen lds
    s_add_u32 m0, s79, 90112
    s_nop 0
    buffer_load_dwordx4 v3, s[16:19], s81 offen lds
    s_mov_b32 s80, 128
    s_add_u32 m0, s78, 49152
    s_nop 0
    buffer_load_dwordx4 v4, s[8:11], s80 offen lds
    s_add_u32 m0, s78, 50176
    s_nop 0
    buffer_load_dwordx4 v5, s[8:11], s80 offen lds
    s_mov_b32 s80, 128
    s_add_u32 m0, s78, 51200
    s_nop 0
    buffer_load_dwordx4 v6, s[8:11], s80 offen lds
    s_add_u32 m0, s78, 52224
    s_nop 0
    buffer_load_dwordx4 v7, s[8:11], s80 offen lds
    s_and_b32 s40, s2, 31
    s_lshr_b32 s41, s2, 5
    s_lshl_b32 s41, s41, 3
    v_and_b32 v116, 255, v0
    v_lshrrev_b32 v117, 8, v0
    v_lshlrev_b32 v117, 2, v117
    v_add_u32 v117, s41, v117
    v_lshlrev_b32 v118, 5, v117
    v_add_u32 v118, s40, v118
    v_mul_u32_u24 v118, 450, v118
    v_lshl_add_u32 v118, v116, 1, v118
    s_mov_b32 s42, 14400
    s_mov_b32 s43, 28800
    s_mov_b32 s44, 43200
    buffer_load_ushort v100, v118, s[24:27], 0 offen
    buffer_load_ushort v101, v118, s[24:27], s42 offen
    buffer_load_ushort v102, v118, s[24:27], s43 offen
    buffer_load_ushort v103, v118, s[24:27], s44 offen
    buffer_load_ushort v104, v118, s[28:31], 0 offen
    buffer_load_ushort v105, v118, s[28:31], s42 offen
    buffer_load_ushort v106, v118, s[28:31], s43 offen
    buffer_load_ushort v107, v118, s[28:31], s44 offen
    v_lshlrev_b32 v118, 5, v116
    v_add_u32 v118, s40, v118
    v_lshl_add_u32 v118, v118, 6, v117
    v_lshlrev_b32 v118, 2, v118
    v_add_u32 v118, 0x900000, v118
    s_lshl_b32 s45, s2, 3
    s_add_u32 s45, s45, s36
    s_mul_i32 s46, s45, 896
    v_lshlrev_b32 v119, 4, v1
    v_add_u32 v120, s46, v119
    v_mov_b32 v121, 0x7ffffff0
    v_cmp_gt_u32 vcc, 56, v1
    s_nop 1
    v_cndmask_b32 v120, v121, v120, vcc
    buffer_load_dwordx4 v[108:111], v120, s[8:11], 0 offen
    buffer_load_dwordx4 v[112:115], v119, s[32:35], 0 offen
    s_mov_b32 s53, 0x7ffffff0
    s_cmp_ge_u32 s45, 38
    s_cbranch_scc1 TJ1_E
    s_lshl_b32 s53, s45, 10
    s_add_u32 s53, s53, 0xb80000
    s_cmp_ge_u32 s45, 22
    s_cbranch_scc1 TJ1_F
    v_and_b32 v129, 31, v1
    v_lshrrev_b32 v130, 5, v1
    s_mov_b32 s48, s45
    s_cmp_ge_u32 s48, 6
    s_cbranch_scc1 TJ1_X
    s_mov_b32 s52, 0x3d000000
    s_mov_b32 s47, 0
    s_and_b32 s49, s48, 1
    s_lshl_b32 s49, s49, 4
    s_lshr_b32 s50, s48, 1
    s_cmp_eq_u32 s50, 1
    s_cselect_b32 s51, 0x3e800000, 0
    s_cmp_eq_u32 s50, 2
    s_cselect_b32 s50, 0xbe800000, s51
    s_branch TJ1_C
TJ1_X:
    s_sub_u32 s48, s48, 6
    s_mov_b32 s52, 0x3c800000
    s_lshr_b32 s47, s48, 2
    s_and_b32 s47, s47, 1
    s_lshl_b32 s47, s47, 5
    s_and_b32 s49, s48, 3
    s_lshl_b32 s49, s49, 4
    s_cmp_ge_u32 s48, 8
    s_cselect_b32 s50, 0x3e800000, 0
TJ1_C:
    v_add_u32 v129, s47, v129
    v_cvt_f32_u32 v129, v129
    v_mul_f32 v129, s52, v129
    v_lshlrev_b32 v130, 2, v130
    v_add_u32 v130, s49, v130
    v_cvt_f32_u32 v130, v130
    v_mov_b32 v131, s50
    v_add_f32 v144, 0x00000000, v130
    v_fma_f32 v136, v144, v129, v131
    v_cos_f32 v136, v136
    v_add_f32 v144, 0x3f800000, v130
    v_fma_f32 v137, v144, v129, v131
    v_cos_f32 v137, v137
    v_add_f32 v144, 0x40000000, v130
    v_fma_f32 v138, v144, v129, v131
    v_cos_f32 v138, v138
    v_add_f32 v144, 0x40400000, v130
    v_fma_f32 v139, v144, v129, v131
    v_cos_f32 v139, v139
    v_add_f32 v144, 0x41000000, v130
    v_fma_f32 v140, v144, v129, v131
    v_cos_f32 v140, v140
    v_add_f32 v144, 0x41100000, v130
    v_fma_f32 v141, v144, v129, v131
    v_cos_f32 v141, v141
    v_add_f32 v144, 0x41200000, v130
    v_fma_f32 v142, v144, v129, v131
    v_cos_f32 v142, v142
    v_add_f32 v144, 0x41300000, v130
    v_fma_f32 v143, v144, v129, v131
    v_cos_f32 v143, v143
    v_cvt_pk_bf16_f32 v124, v136, v137
    v_cvt_pk_bf16_f32 v125, v138, v139
    v_cvt_pk_bf16_f32 v126, v140, v141
    v_cvt_pk_bf16_f32 v127, v142, v143
    s_branch TJ1_E
TJ1_F:
    s_sub_u32 s48, s45, 22
    s_lshl_b32 s48, s48, 4
    v_lshrrev_b32 v144, 2, v1
    v_add_u32 v144, s48, v144
    v_cmp_lt_u32 vcc, 224, v144
    s_nop 1
    v_cndmask_b32 v124, 0, 1, vcc
TJ1_E:
    v_lshlrev_b32 v128, 4, v1
    v_add_u32 v128, s53, v128
    s_waitcnt vmcnt(16)
    s_barrier
    ds_read_b64_tr_b16 v[32:33], v26 offset:32768
    ds_read_b64_tr_b16 v[34:35], v26 offset:33280
    ds_read_b64_tr_b16 v[36:37], v26 offset:40960
    ds_read_b64_tr_b16 v[38:39], v26 offset:41472
    ds_read_b128 v[40:43], v14 offset:0
    ds_read_b128 v[44:47], v14 offset:4096
    ds_read_b64_tr_b16 v[48:49], v26 offset:34816
    ds_read_b64_tr_b16 v[50:51], v26 offset:35328
    ds_read_b64_tr_b16 v[52:53], v26 offset:43008
    ds_read_b64_tr_b16 v[54:55], v26 offset:43520
    ds_read_b128 v[56:59], v15 offset:0
    ds_read_b128 v[60:63], v15 offset:4096
    s_waitcnt lgkmcnt(6)
    v_mfma_f32_32x32x16_bf16 v[160:175], v[32:35], v[40:43], 0
    v_mfma_f32_32x32x16_bf16 v[176:191], v[32:35], v[44:47], 0
    v_mfma_f32_32x32x16_bf16 v[192:207], v[36:39], v[40:43], 0
    v_mfma_f32_32x32x16_bf16 v[208:223], v[36:39], v[44:47], 0
    s_mov_b32 s81, 458752
    s_add_u32 m0, s79, 131072
    s_nop 0
    buffer_load_dwordx4 v3, s[12:15], s81 offen lds
    s_add_u32 m0, s79, 139264
    s_nop 0
    buffer_load_dwordx4 v3, s[16:19], s81 offen lds
    ds_read_b64_tr_b16 v[32:33], v26 offset:36864
    ds_read_b64_tr_b16 v[34:35], v26 offset:37376
    ds_read_b64_tr_b16 v[36:37], v26 offset:45056
    ds_read_b64_tr_b16 v[38:39], v26 offset:45568
    ds_read_b128 v[40:43], v16 offset:0
    ds_read_b128 v[44:47], v16 offset:4096
    s_waitcnt lgkmcnt(6)
    v_mfma_f32_32x32x16_bf16 v[160:175], v[48:51], v[56:59], v[160:175]
    v_mfma_f32_32x32x16_bf16 v[176:191], v[48:51], v[60:63], v[176:191]
    v_mfma_f32_32x32x16_bf16 v[192:207], v[52:55], v[56:59], v[192:207]
    v_mfma_f32_32x32x16_bf16 v[208:223], v[52:55], v[60:63], v[208:223]
    s_mov_b32 s80, 256
    s_add_u32 m0, s78, 98304
    s_nop 0
    buffer_load_dwordx4 v4, s[8:11], s80 offen lds
    s_add_u32 m0, s78, 99328
    s_nop 0
    buffer_load_dwordx4 v5, s[8:11], s80 offen lds
    ds_read_b64_tr_b16 v[48:49], v26 offset:38912
    ds_read_b64_tr_b16 v[50:51], v26 offset:39424
    ds_read_b64_tr_b16 v[52:53], v26 offset:47104
    ds_read_b64_tr_b16 v[54:55], v26 offset:47616
    ds_read_b128 v[56:59], v17 offset:0
    ds_read_b128 v[60:63], v17 offset:4096
    s_waitcnt lgkmcnt(6)
    v_mfma_f32_32x32x16_bf16 v[160:175], v[32:35], v[40:43], v[160:175]
    v_mfma_f32_32x32x16_bf16 v[176:191], v[32:35], v[44:47], v[176:191]
    v_mfma_f32_32x32x16_bf16 v[192:207], v[36:39], v[40:43], v[192:207]
    v_mfma_f32_32x32x16_bf16 v[208:223], v[36:39], v[44:47], v[208:223]
    s_mov_b32 s80, 256
    s_add_u32 m0, s78, 100352
    s_nop 0
    buffer_load_dwordx4 v6, s[8:11], s80 offen lds
    s_add_u32 m0, s78, 101376
    s_nop 0
    buffer_load_dwordx4 v7, s[8:11], s80 offen lds
    s_waitcnt vmcnt(16) lgkmcnt(0)
    s_barrier
    ds_read_b64_tr_b16 v[32:33], v27 offset:32768
    ds_read_b64_tr_b16 v[34:35], v27 offset:33280
    ds_read_b64_tr_b16 v[36:37], v27 offset:40960
    ds_read_b64_tr_b16 v[38:39], v27 offset:41472
    ds_read_b128 v[40:43], v18 offset:0
    ds_read_b128 v[44:47], v18 offset:4096
    v_mfma_f32_32x32x16_bf16 v[160:175], v[48:51], v[56:59], v[160:175]
    v_mfma_f32_32x32x16_bf16 v[176:191], v[48:51], v[60:63], v[176:191]
    v_mfma_f32_32x32x16_bf16 v[192:207], v[52:55], v[56:59], v[192:207]
    v_mfma_f32_32x32x16_bf16 v[208:223], v[52:55], v[60:63], v[208:223]
    ds_read_b64_tr_b16 v[48:49], v27 offset:34816
    ds_read_b64_tr_b16 v[50:51], v27 offset:35328
    ds_read_b64_tr_b16 v[52:53], v27 offset:43008
    ds_read_b64_tr_b16 v[54:55], v27 offset:43520
    ds_read_b128 v[56:59], v19 offset:0
    ds_read_b128 v[60:63], v19 offset:4096
    s_waitcnt lgkmcnt(6)
    v_mfma_f32_32x32x16_bf16 v[160:175], v[32:35], v[40:43], v[160:175]
    v_mfma_f32_32x32x16_bf16 v[176:191], v[32:35], v[44:47], v[176:191]
    v_mfma_f32_32x32x16_bf16 v[192:207], v[36:39], v[40:43], v[192:207]
    v_mfma_f32_32x32x16_bf16 v[208:223], v[36:39], v[44:47], v[208:223]
    s_mov_b32 s81, 688128
    s_add_u32 m0, s79, 32768
    s_nop 0
    buffer_load_dwordx4 v3, s[12:15], s81 offen lds
    s_add_u32 m0, s79, 40960
    s_nop 0
    buffer_load_dwordx4 v3, s[16:19], s81 offen lds
    ds_read_b64_tr_b16 v[32:33], v27 offset:36864
    ds_read_b64_tr_b16 v[34:35], v27 offset:37376
    ds_read_b64_tr_b16 v[36:37], v27 offset:45056
    ds_read_b64_tr_b16 v[38:39], v27 offset:45568
    ds_read_b128 v[40:43], v20 offset:0
    ds_read_b128 v[44:47], v20 offset:4096
    s_waitcnt lgkmcnt(6)
    v_mfma_f32_32x32x16_bf16 v[160:175], v[48:51], v[56:59], v[160:175]
    v_mfma_f32_32x32x16_bf16 v[176:191], v[48:51], v[60:63], v[176:191]
    v_mfma_f32_32x32x16_bf16 v[192:207], v[52:55], v[56:59], v[192:207]
    v_mfma_f32_32x32x16_bf16 v[208:223], v[52:55], v[60:63], v[208:223]
    s_mov_b32 s80, 384
    s_add_u32 m0, s78, 0
    s_nop 0
    buffer_load_dwordx4 v4, s[8:11], s80 offen lds
    s_add_u32 m0, s78, 1024
    s_nop 0
    buffer_load_dwordx4 v5, s[8:11], s80 offen lds
    ds_read_b64_tr_b16 v[48:49], v27 offset:38912
    ds_read_b64_tr_b16 v[50:51], v27 offset:39424
    ds_read_b64_tr_b16 v[52:53], v27 offset:47104
    ds_read_b64_tr_b16 v[54:55], v27 offset:47616
    ds_read_b128 v[56:59], v21 offset:0
    ds_read_b128 v[60:63], v21 offset:4096
    s_waitcnt lgkmcnt(6)
    v_mfma_f32_32x32x16_bf16 v[160:175], v[32:35], v[40:43], v[160:175]
    v_mfma_f32_32x32x16_bf16 v[176:191], v[32:35], v[44:47], v[176:191]
    v_mfma_f32_32x32x16_bf16 v[192:207], v[36:39], v[40:43], v[192:207]
    v_mfma_f32_32x32x16_bf16 v[208:223], v[36:39], v[44:47], v[208:223]
    s_mov_b32 s80, 384
    s_add_u32 m0, s78, 2048
    s_nop 0
    buffer_load_dwordx4 v6, s[8:11], s80 offen lds
    s_add_u32 m0, s78, 3072
    s_nop 0
    buffer_load_dwordx4 v7, s[8:11], s80 offen lds
    s_waitcnt vmcnt(6) lgkmcnt(0)
    s_barrier
    ds_read_b64_tr_b16 v[32:33], v28 offset:32768
    ds_read_b64_tr_b16 v[34:35], v28 offset:33280
    ds_read_b64_tr_b16 v[36:37], v28 offset:40960
    ds_read_b64_tr_b16 v[38:39], v28 offset:41472
    ds_read_b128 v[40:43], v22 offset:0
    ds_read_b128 v[44:47], v22 offset:4096
    v_mfma_f32_32x32x16_bf16 v[160:175], v[48:51], v[56:59], v[160:175]
    v_mfma_f32_32x32x16_bf16 v[176:191], v[48:51], v[60:63], v[176:191]
    v_mfma_f32_32x32x16_bf16 v[192:207], v[52:55], v[56:59], v[192:207]
    v_mfma_f32_32x32x16_bf16 v[208:223], v[52:55], v[60:63], v[208:223]
    ds_read_b64_tr_b16 v[48:49], v28 offset:34816
    ds_read_b64_tr_b16 v[50:51], v28 offset:35328
    ds_read_b64_tr_b16 v[52:53], v28 offset:43008
    ds_read_b64_tr_b16 v[54:55], v28 offset:43520
    ds_read_b128 v[56:59], v23 offset:0
    ds_read_b128 v[60:63], v23 offset:4096
    s_waitcnt lgkmcnt(6)
    v_mfma_f32_32x32x16_bf16 v[160:175], v[32:35], v[40:43], v[160:175]
    v_mfma_f32_32x32x16_bf16 v[176:191], v[32:35], v[44:47], v[176:191]
    v_mfma_f32_32x32x16_bf16 v[192:207], v[36:39], v[40:43], v[192:207]
    v_mfma_f32_32x32x16_bf16 v[208:223], v[36:39], v[44:47], v[208:223]
    v_lshl_or_b32 v100, v104, 16, v100
    v_lshl_or_b32 v101, v105, 16, v101
    v_lshl_or_b32 v102, v106, 16, v102
    v_lshl_or_b32 v103, v107, 16, v103
    v_mov_b32 v136, 0
    v_lshlrev_b32 v137, 16, v108
    v_lshlrev_b32 v138, 16, v112
    v_fmac_f32 v136, v137, v138
    v_and_b32 v137, 0xffff0000, v108
    v_and_b32 v138, 0xffff0000, v112
    v_fmac_f32 v136, v137, v138
    v_lshlrev_b32 v137, 16, v109
    v_lshlrev_b32 v138, 16, v113
    v_fmac_f32 v136, v137, v138
    v_and_b32 v137, 0xffff0000, v109
    v_and_b32 v138, 0xffff0000, v113
    v_fmac_f32 v136, v137, v138
    v_lshlrev_b32 v137, 16, v110
    v_lshlrev_b32 v138, 16, v114
    v_fmac_f32 v136, v137, v138
    v_and_b32 v137, 0xffff0000, v110
    v_and_b32 v138, 0xffff0000, v114
    v_fmac_f32 v136, v137, v138
    v_lshlrev_b32 v137, 16, v111
    v_lshlrev_b32 v138, 16, v115
    v_fmac_f32 v136, v137, v138
    v_and_b32 v137, 0xffff0000, v111
    v_and_b32 v138, 0xffff0000, v115
    v_fmac_f32 v136, v137, v138
    s_nop 1
    v_add_f32_dpp v136, v136, v136 row_shr:1 row_mask:0xf bank_mask:0xf bound_ctrl:0
    s_nop 1
    v_add_f32_dpp v136, v136, v136 row_shr:2 row_mask:0xf bank_mask:0xf bound_ctrl:0
    s_nop 1
    v_add_f32_dpp v136, v136, v136 row_shr:4 row_mask:0xf bank_mask:0xf bound_ctrl:0
    s_nop 1
    v_add_f32_dpp v136, v136, v136 row_shr:8 row_mask:0xf bank_mask:0xf bound_ctrl:0
    s_nop 0
    v_readlane_b32 s54, v136, 15
    v_readlane_b32 s55, v136, 31
    v_readlane_b32 s56, v136, 47
    v_readlane_b32 s57, v136, 63
    v_mov_b32 v136, s54
    v_add_f32 v136, s55, v136
    v_add_f32 v136, s56, v136
    v_add_f32 v136, s57, v136
    v_mul_f32 v136, 0xbfb8aa3b, v136
    v_exp_f32 v136, v136
    s_nop 0
    v_add_f32 v136, 1.0, v136
    v_rcp_f32 v136, v136
    s_and_b32 s54, s45, 63
    s_lshl_b32 s54, s54, 5
    s_lshr_b32 s55, s45, 6
    s_add_u32 s54, s54, s55
    s_lshl_b32 s54, s54, 2
    s_add_u32 s54, s54, 0xb00000
    v_mov_b32 v137, s54
    buffer_store_dwordx4 v[124:127], v128, s[20:23], 0 offen sc0 sc1
    v_cmp_gt_u32 vcc, 225, v116
    s_nop 1
    s_and_saveexec_b64 s[58:59], vcc
    buffer_store_dwordx4 v[100:103], v118, s[20:23], 0 offen sc0 sc1
    s_mov_b64 exec, 1
    buffer_store_dword v136, v137, s[20:23], 0 offen
    s_mov_b64 exec, s[58:59]
    s_mov_b32 s81, 917504
    s_add_u32 m0, s79, 81920
    s_nop 0
    buffer_load_dwordx4 v3, s[12:15], s81 offen lds
    s_add_u32 m0, s79, 90112
    s_nop 0
    buffer_load_dwordx4 v3, s[16:19], s81 offen lds
    ds_read_b64_tr_b16 v[32:33], v28 offset:36864
    ds_read_b64_tr_b16 v[34:35], v28 offset:37376
    ds_read_b64_tr_b16 v[36:37], v28 offset:45056
    ds_read_b64_tr_b16 v[38:39], v28 offset:45568
    ds_read_b128 v[40:43], v24 offset:0
    ds_read_b128 v[44:47], v24 offset:4096
    s_waitcnt lgkmcnt(6)
    v_mfma_f32_32x32x16_bf16 v[160:175], v[48:51], v[56:59], v[160:175]
    v_mfma_f32_32x32x16_bf16 v[176:191], v[48:51], v[60:63], v[176:191]
    v_mfma_f32_32x32x16_bf16 v[192:207], v[52:55], v[56:59], v[192:207]
    v_mfma_f32_32x32x16_bf16 v[208:223], v[52:55], v[60:63], v[208:223]
    s_mov_b32 s80, 512
    s_add_u32 m0, s78, 49152
    s_nop 0
    buffer_load_dwordx4 v4, s[8:11], s80 offen lds
    s_add_u32 m0, s78, 50176
    s_nop 0
    buffer_load_dwordx4 v5, s[8:11], s80 offen lds
    ds_read_b64_tr_b16 v[48:49], v28 offset:38912
    ds_read_b64_tr_b16 v[50:51], v28 offset:39424
    ds_read_b64_tr_b16 v[52:53], v28 offset:47104
    ds_read_b64_tr_b16 v[54:55], v28 offset:47616
    ds_read_b128 v[56:59], v25 offset:0
    ds_read_b128 v[60:63], v25 offset:4096
    s_waitcnt lgkmcnt(6)
    v_mfma_f32_32x32x16_bf16 v[160:175], v[32:35], v[40:43], v[160:175]
    v_mfma_f32_32x32x16_bf16 v[176:191], v[32:35], v[44:47], v[176:191]
    v_mfma_f32_32x32x16_bf16 v[192:207], v[36:39], v[40:43], v[192:207]
    v_mfma_f32_32x32x16_bf16 v[208:223], v[36:39], v[44:47], v[208:223]
    s_mov_b32 s80, 512
    s_add_u32 m0, s78, 51200
    s_nop 0
    buffer_load_dwordx4 v6, s[8:11], s80 offen lds
    s_add_u32 m0, s78, 52224
    s_nop 0
    buffer_load_dwordx4 v7, s[8:11], s80 offen lds
    s_waitcnt vmcnt(9) lgkmcnt(0)
    s_barrier
    ds_read_b64_tr_b16 v[32:33], v26 offset:32768
    ds_read_b64_tr_b16 v[34:35], v26 offset:33280
    ds_read_b64_tr_b16 v[36:37], v26 offset:40960
    ds_read_b64_tr_b16 v[38:39], v26 offset:41472
    ds_read_b128 v[40:43], v14 offset:0
    ds_read_b128 v[44:47], v14 offset:4096
    v_mfma_f32_32x32x16_bf16 v[160:175], v[48:51], v[56:59], v[160:175]
    v_mfma_f32_32x32x16_bf16 v[176:191], v[48:51], v[60:63], v[176:191]
    v_mfma_f32_32x32x16_bf16 v[192:207], v[52:55], v[56:59], v[192:207]
    v_mfma_f32_32x32x16_bf16 v[208:223], v[52:55], v[60:63], v[208:223]
    ds_read_b64_tr_b16 v[48:49], v26 offset:34816
    ds_read_b64_tr_b16 v[50:51], v26 offset:35328
    ds_read_b64_tr_b16 v[52:53], v26 offset:43008
    ds_read_b64_tr_b16 v[54:55], v26 offset:43520
    ds_read_b128 v[56:59], v15 offset:0
    ds_read_b128 v[60:63], v15 offset:4096
    s_waitcnt lgkmcnt(6)
    v_mfma_f32_32x32x16_bf16 v[160:175], v[32:35], v[40:43], v[160:175]
    v_mfma_f32_32x32x16_bf16 v[176:191], v[32:35], v[44:47], v[176:191]
    v_mfma_f32_32x32x16_bf16 v[192:207], v[36:39], v[40:43], v[192:207]
    v_mfma_f32_32x32x16_bf16 v[208:223], v[36:39], v[44:47], v[208:223]
    s_mov_b32 s81, 1146880
    s_add_u32 m0, s79, 131072
    s_nop 0
    buffer_load_dwordx4 v3, s[12:15], s81 offen lds
    s_add_u32 m0, s79, 139264
    s_nop 0
    buffer_load_dwordx4 v3, s[16:19], s81 offen lds
    ds_read_b64_tr_b16 v[32:33], v26 offset:36864
    ds_read_b64_tr_b16 v[34:35], v26 offset:37376
    ds_read_b64_tr_b16 v[36:37], v26 offset:45056
    ds_read_b64_tr_b16 v[38:39], v26 offset:45568
    ds_read_b128 v[40:43], v16 offset:0
    ds_read_b128 v[44:47], v16 offset:4096
    s_waitcnt lgkmcnt(6)
    v_mfma_f32_32x32x16_bf16 v[160:175], v[48:51], v[56:59], v[160:175]
    v_mfma_f32_32x32x16_bf16 v[176:191], v[48:51], v[60:63], v[176:191]
    v_mfma_f32_32x32x16_bf16 v[192:207], v[52:55], v[56:59], v[192:207]
    v_mfma_f32_32x32x16_bf16 v[208:223], v[52:55], v[60:63], v[208:223]
    s_mov_b32 s80, 640
    s_add_u32 m0, s78, 98304
    s_nop 0
    buffer_load_dwordx4 v4, s[8:11], s80 offen lds
    s_add_u32 m0, s78, 99328
    s_nop 0
    buffer_load_dwordx4 v5, s[8:11], s80 offen lds
    ds_read_b64_tr_b16 v[48:49], v26 offset:38912
    ds_read_b64_tr_b16 v[50:51], v26 offset:39424
    ds_read_b64_tr_b16 v[52:53], v26 offset:47104
    ds_read_b64_tr_b16 v[54:55], v26 offset:47616
    ds_read_b128 v[56:59], v17 offset:0
    ds_read_b128 v[60:63], v17 offset:4096
    s_waitcnt lgkmcnt(6)
    v_mfma_f32_32x32x16_bf16 v[160:175], v[32:35], v[40:43], v[160:175]
    v_mfma_f32_32x32x16_bf16 v[176:191], v[32:35], v[44:47], v[176:191]
    v_mfma_f32_32x32x16_bf16 v[192:207], v[36:39], v[40:43], v[192:207]
    v_mfma_f32_32x32x16_bf16 v[208:223], v[36:39], v[44:47], v[208:223]
    s_mov_b32 s80, 640
    s_add_u32 m0, s78, 100352
    s_nop 0
    buffer_load_dwordx4 v6, s[8:11], s80 offen lds
    s_add_u32 m0, s78, 101376
    s_nop 0
    buffer_load_dwordx4 v7, s[8:11], s80 offen lds
    s_waitcnt vmcnt(6) lgkmcnt(0)
    s_barrier
    ds_read_b64_tr_b16 v[32:33], v27 offset:32768
    ds_read_b64_tr_b16 v[34:35], v27 offset:33280
    ds_read_b64_tr_b16 v[36:37], v27 offset:40960
    ds_read_b64_tr_b16 v[38:39], v27 offset:41472
    ds_read_b128 v[40:43], v18 offset:0
    ds_read_b128 v[44:47], v18 offset:4096
    v_mfma_f32_32x32x16_bf16 v[160:175], v[48:51], v[56:59], v[160:175]
    v_mfma_f32_32x32x16_bf16 v[176:191], v[48:51], v[60:63], v[176:191]
    v_mfma_f32_32x32x16_bf16 v[192:207], v[52:55], v[56:59], v[192:207]
    v_mfma_f32_32x32x16_bf16 v[208:223], v[52:55], v[60:63], v[208:223]
    ds_read_b64_tr_b16 v[48:49], v27 offset:34816
    ds_read_b64_tr_b16 v[50:51], v27 offset:35328
    ds_read_b64_tr_b16 v[52:53], v27 offset:43008
    ds_read_b64_tr_b16 v[54:55], v27 offset:43520
    ds_read_b128 v[56:59], v19 offset:0
    ds_read_b128 v[60:63], v19 offset:4096
    s_waitcnt lgkmcnt(6)
    v_mfma_f32_32x32x16_bf16 v[160:175], v[32:35], v[40:43], v[160:175]
    v_mfma_f32_32x32x16_bf16 v[176:191], v[32:35], v[44:47], v[176:191]
    v_mfma_f32_32x32x16_bf16 v[192:207], v[36:39], v[40:43], v[192:207]
    v_mfma_f32_32x32x16_bf16 v[208:223], v[36:39], v[44:47], v[208:223]
    s_mov_b32 s81, 1376256
    s_add_u32 m0, s79, 32768
    s_nop 0
    buffer_load_dwordx4 v3, s[12:15], s81 offen lds
    s_add_u32 m0, s79, 40960
    s_nop 0
    buffer_load_dwordx4 v3, s[16:19], s81 offen lds
    ds_read_b64_tr_b16 v[32:33], v27 offset:36864
    ds_read_b64_tr_b16 v[34:35], v27 offset:37376
    ds_read_b64_tr_b16 v[36:37], v27 offset:45056
    ds_read_b64_tr_b16 v[38:39], v27 offset:45568
    ds_read_b128 v[40:43], v20 offset:0
    ds_read_b128 v[44:47], v20 offset:4096
    s_waitcnt lgkmcnt(6)
    v_mfma_f32_32x32x16_bf16 v[160:175], v[48:51], v[56:59], v[160:175]
    v_mfma_f32_32x32x16_bf16 v[176:191], v[48:51], v[60:63], v[176:191]
    v_mfma_f32_32x32x16_bf16 v[192:207], v[52:55], v[56:59], v[192:207]
    v_mfma_f32_32x32x16_bf16 v[208:223], v[52:55], v[60:63], v[208:223]
    s_mov_b32 s80, 768
    s_add_u32 m0, s78, 0
    s_nop 0
    buffer_load_dwordx4 v4, s[8:11], s80 offen lds
    s_add_u32 m0, s78, 1024
    s_nop 0
    buffer_load_dwordx4 v5, s[8:11], s80 offen lds
    ds_read_b64_tr_b16 v[48:49], v27 offset:38912
    ds_read_b64_tr_b16 v[50:51], v27 offset:39424
    ds_read_b64_tr_b16 v[52:53], v27 offset:47104
    ds_read_b64_tr_b16 v[54:55], v27 offset:47616
    ds_read_b128 v[56:59], v21 offset:0
    ds_read_b128 v[60:63], v21 offset:4096
    s_waitcnt lgkmcnt(6)
    v_mfma_f32_32x32x16_bf16 v[160:175], v[32:35], v[40:43], v[160:175]
    v_mfma_f32_32x32x16_bf16 v[176:191], v[32:35], v[44:47], v[176:191]
    v_mfma_f32_32x32x16_bf16 v[192:207], v[36:39], v[40:43], v[192:207]
    v_mfma_f32_32x32x16_bf16 v[208:223], v[36:39], v[44:47], v[208:223]
    s_mov_b32 s80, 768
    s_add_u32 m0, s78, 2048
    s_nop 0
    buffer_load_dwordx4 v6, s[8:11], s80 offen lds
    s_add_u32 m0, s78, 3072
    s_nop 0
    buffer_load_dwordx4 v7, s[8:11], s80 offen lds
    s_waitcnt vmcnt(6) lgkmcnt(0)
    s_barrier
    ds_read_b64_tr_b16 v[32:33], v28 offset:32768
    ds_read_b64_tr_b16 v[34:35], v28 offset:33280
    ds_read_b64_tr_b16 v[36:37], v28 offset:40960
    ds_read_b64_tr_b16 v[38:39], v28 offset:41472
    ds_read_b128 v[40:43], v22 offset:0
    ds_read_b128 v[44:47], v22 offset:4096
    v_mfma_f32_32x32x16_bf16 v[160:175], v[48:51], v[56:59], v[160:175]
    v_mfma_f32_32x32x16_bf16 v[176:191], v[48:51], v[60:63], v[176:191]
    v_mfma_f32_32x32x16_bf16 v[192:207], v[52:55], v[56:59], v[192:207]
    v_mfma_f32_32x32x16_bf16 v[208:223], v[52:55], v[60:63], v[208:223]
    ds_read_b64_tr_b16 v[48:49], v28 offset:34816
    ds_read_b64_tr_b16 v[50:51], v28 offset:35328
    ds_read_b64_tr_b16 v[52:53], v28 offset:43008
    ds_read_b64_tr_b16 v[54:55], v28 offset:43520
    ds_read_b128 v[56:59], v23 offset:0
    ds_read_b128 v[60:63], v23 offset:4096
    s_waitcnt lgkmcnt(6)
    v_mfma_f32_32x32x16_bf16 v[160:175], v[32:35], v[40:43], v[160:175]
    v_mfma_f32_32x32x16_bf16 v[176:191], v[32:35], v[44:47], v[176:191]
    v_mfma_f32_32x32x16_bf16 v[192:207], v[36:39], v[40:43], v[192:207]
    v_mfma_f32_32x32x16_bf16 v[208:223], v[36:39], v[44:47], v[208:223]
    s_lshr_b32 s86, s2, 3
    s_lshl_b32 s86, s86, 3
    s_add_u32 s86, s86, s36
    s_mul_i32 s86, s86, 6272
    v_lshlrev_b32 v146, 7, v1
    buffer_load_dword v147, v146, s[64:67], s86 offen
    ds_read_b64_tr_b16 v[32:33], v28 offset:36864
    ds_read_b64_tr_b16 v[34:35], v28 offset:37376
    ds_read_b64_tr_b16 v[36:37], v28 offset:45056
    ds_read_b64_tr_b16 v[38:39], v28 offset:45568
    ds_read_b128 v[40:43], v24 offset:0
    ds_read_b128 v[44:47], v24 offset:4096
    s_waitcnt lgkmcnt(6)
    v_mfma_f32_32x32x16_bf16 v[160:175], v[48:51], v[56:59], v[160:175]
    v_mfma_f32_32x32x16_bf16 v[176:191], v[48:51], v[60:63], v[176:191]
    v_mfma_f32_32x32x16_bf16 v[192:207], v[52:55], v[56:59], v[192:207]
    v_mfma_f32_32x32x16_bf16 v[208:223], v[52:55], v[60:63], v[208:223]
    ds_read_b64_tr_b16 v[48:49], v28 offset:38912
    ds_read_b64_tr_b16 v[50:51], v28 offset:39424
    ds_read_b64_tr_b16 v[52:53], v28 offset:47104
    ds_read_b64_tr_b16 v[54:55], v28 offset:47616
    ds_read_b128 v[56:59], v25 offset:0
    ds_read_b128 v[60:63], v25 offset:4096
    s_waitcnt lgkmcnt(6)
    v_mfma_f32_32x32x16_bf16 v[160:175], v[32:35], v[40:43], v[160:175]
    v_mfma_f32_32x32x16_bf16 v[176:191], v[32:35], v[44:47], v[176:191]
    v_mfma_f32_32x32x16_bf16 v[192:207], v[36:39], v[40:43], v[192:207]
    v_mfma_f32_32x32x16_bf16 v[208:223], v[36:39], v[44:47], v[208:223]
    s_waitcnt vmcnt(1) lgkmcnt(0)
    s_barrier
    ds_read_b64_tr_b16 v[32:33], v26 offset:32768
    ds_read_b64_tr_b16 v[34:35], v26 offset:33280
    ds_read_b64_tr_b16 v[36:37], v26 offset:40960
    ds_read_b64_tr_b16 v[38:39], v26 offset:41472
    ds_read_b128 v[40:43], v14 offset:0
    ds_read_b128 v[44:47], v14 offset:4096
    v_mfma_f32_32x32x16_bf16 v[160:175], v[48:51], v[56:59], v[160:175]
    v_mfma_f32_32x32x16_bf16 v[176:191], v[48:51], v[60:63], v[176:191]
    v_mfma_f32_32x32x16_bf16 v[192:207], v[52:55], v[56:59], v[192:207]
    v_mfma_f32_32x32x16_bf16 v[208:223], v[52:55], v[60:63], v[208:223]
    ds_read_b64_tr_b16 v[48:49], v26 offset:34816
    ds_read_b64_tr_b16 v[50:51], v26 offset:35328
    ds_read_b64_tr_b16 v[52:53], v26 offset:43008
    ds_read_b64_tr_b16 v[54:55], v26 offset:43520
    ds_read_b128 v[56:59], v15 offset:0
    ds_read_b128 v[60:63], v15 offset:4096
    s_waitcnt lgkmcnt(6)
    v_mfma_f32_32x32x16_bf16 v[160:175], v[32:35], v[40:43], v[160:175]
    v_mfma_f32_32x32x16_bf16 v[176:191], v[32:35], v[44:47], v[176:191]
    v_mfma_f32_32x32x16_bf16 v[192:207], v[36:39], v[40:43], v[192:207]
    v_mfma_f32_32x32x16_bf16 v[208:223], v[36:39], v[44:47], v[208:223]
    ds_read_b64_tr_b16 v[32:33], v26 offset:36864
    ds_read_b64_tr_b16 v[34:35], v26 offset:37376
    ds_read_b64_tr_b16 v[36:37], v26 offset:45056
    ds_read_b64_tr_b16 v[38:39], v26 offset:45568
    ds_read_b128 v[40:43], v16 offset:0
    ds_read_b128 v[44:47], v16 offset:4096
    s_waitcnt lgkmcnt(6)
    v_mfma_f32_32x32x16_bf16 v[160:175], v[48:51], v[56:59], v[160:175]
    v_mfma_f32_32x32x16_bf16 v[176:191], v[48:51], v[60:63], v[176:191]
    v_mfma_f32_32x32x16_bf16 v[192:207], v[52:55], v[56:59], v[192:207]
    v_mfma_f32_32x32x16_bf16 v[208:223], v[52:55], v[60:63], v[208:223]
    ds_read_b64_tr_b16 v[48:49], v26 offset:38912
    ds_read_b64_tr_b16 v[50:51], v26 offset:39424
    ds_read_b64_tr_b16 v[52:53], v26 offset:47104
    ds_read_b64_tr_b16 v[54:55], v26 offset:47616
    ds_read_b128 v[56:59], v17 offset:0
    ds_read_b128 v[60:63], v17 offset:4096
    s_waitcnt lgkmcnt(6)
    v_mfma_f32_32x32x16_bf16 v[160:175], v[32:35], v[40:43], v[160:175]
    v_mfma_f32_32x32x16_bf16 v[176:191], v[32:35], v[44:47], v[176:191]
    v_mfma_f32_32x32x16_bf16 v[192:207], v[36:39], v[40:43], v[192:207]
    v_mfma_f32_32x32x16_bf16 v[208:223], v[36:39], v[44:47], v[208:223]
    s_waitcnt lgkmcnt(0)
    v_mfma_f32_32x32x16_bf16 v[160:175], v[48:51], v[56:59], v[160:175]
    v_mfma_f32_32x32x16_bf16 v[176:191], v[48:51], v[60:63], v[176:191]
    v_mfma_f32_32x32x16_bf16 v[192:207], v[52:55], v[56:59], v[192:207]
    v_mfma_f32_32x32x16_bf16 v[208:223], v[52:55], v[60:63], v[208:223]
    v_mov_b32 v64, 0xc0135761
    s_lshl_b32 s84, s74, 3
    s_lshl_b32 s85, s82, 1
    s_add_u32 s84, s84, s85
    s_mul_i32 s84, s84, 112
    s_lshl_b32 s85, s75, 1
    s_add_u32 s85, s85, s83
    s_lshl_b32 s85, s85, 1
    s_add_u32 s84, s84, s85
    s_lshl_b32 s84, s84, 10
    s_add_u32 s85, s84, 114688
    v_lshlrev_b32 v65, 4, v1
    v_mul_f32 v66, v160, v160
    v_mul_f32 v67, v161, v161
    v_mul_f32 v68, v162, v162
    v_mul_f32 v69, v163, v163
    v_fmamk_f32 v66, v66, 0xbdd2d3e8, v64
    v_fmamk_f32 v67, v67, 0xbdd2d3e8, v64
    v_fmamk_f32 v68, v68, 0xbdd2d3e8, v64
    v_fmamk_f32 v69, v69, 0xbdd2d3e8, v64
    v_mul_f32 v66, v66, v160
    v_mul_f32 v67, v67, v161
    v_mul_f32 v68, v68, v162
    v_mul_f32 v69, v69, v163
    v_exp_f32 v66, v66
    v_exp_f32 v67, v67
    v_exp_f32 v68, v68
    v_exp_f32 v69, v69
    v_mul_f32 v70, v160, v192
    v_mul_f32 v71, v161, v193
    v_mul_f32 v72, v162, v194
    v_mul_f32 v73, v163, v195
    v_add_f32 v66, 1.0, v66
    v_add_f32 v67, 1.0, v67
    v_add_f32 v68, 1.0, v68
    v_add_f32 v69, 1.0, v69
    v_rcp_f32 v66, v66
    v_rcp_f32 v67, v67
    v_rcp_f32 v68, v68
    v_rcp_f32 v69, v69
    v_mul_f32 v70, v70, v66
    v_mul_f32 v71, v71, v67
    v_mul_f32 v72, v72, v68
    v_mul_f32 v73, v73, v69
    v_cvt_pk_bf16_f32 v76, v70, v71
    v_cvt_pk_bf16_f32 v77, v72, v73
    v_mul_f32 v66, v164, v164
    v_mul_f32 v67, v165, v165
    v_mul_f32 v68, v166, v166
    v_mul_f32 v69, v167, v167
    v_fmamk_f32 v66, v66, 0xbdd2d3e8, v64
    v_fmamk_f32 v67, v67, 0xbdd2d3e8, v64
    v_fmamk_f32 v68, v68, 0xbdd2d3e8, v64
    v_fmamk_f32 v69, v69, 0xbdd2d3e8, v64
    v_mul_f32 v66, v66, v164
    v_mul_f32 v67, v67, v165
    v_mul_f32 v68, v68, v166
    v_mul_f32 v69, v69, v167
    v_exp_f32 v66, v66
    v_exp_f32 v67, v67
    v_exp_f32 v68, v68
    v_exp_f32 v69, v69
    v_mul_f32 v70, v164, v196
    v_mul_f32 v71, v165, v197
    v_mul_f32 v72, v166, v198
    v_mul_f32 v73, v167, v199
    v_add_f32 v66, 1.0, v66
    v_add_f32 v67, 1.0, v67
    v_add_f32 v68, 1.0, v68
    v_add_f32 v69, 1.0, v69
    v_rcp_f32 v66, v66
    v_rcp_f32 v67, v67
    v_rcp_f32 v68, v68
    v_rcp_f32 v69, v69
    v_mul_f32 v70, v70, v66
    v_mul_f32 v71, v71, v67
    v_mul_f32 v72, v72, v68
    v_mul_f32 v73, v73, v69
    v_cvt_pk_bf16_f32 v78, v70, v71
    v_cvt_pk_bf16_f32 v79, v72, v73
    v_mul_f32 v66, v168, v168
    v_mul_f32 v67, v169, v169
    v_mul_f32 v68, v170, v170
    v_mul_f32 v69, v171, v171
    v_fmamk_f32 v66, v66, 0xbdd2d3e8, v64
    v_fmamk_f32 v67, v67, 0xbdd2d3e8, v64
    v_fmamk_f32 v68, v68, 0xbdd2d3e8, v64
    v_fmamk_f32 v69, v69, 0xbdd2d3e8, v64
    v_mul_f32 v66, v66, v168
    v_mul_f32 v67, v67, v169
    v_mul_f32 v68, v68, v170
    v_mul_f32 v69, v69, v171
    v_exp_f32 v66, v66
    v_exp_f32 v67, v67
    v_exp_f32 v68, v68
    v_exp_f32 v69, v69
    v_mul_f32 v70, v168, v200
    v_mul_f32 v71, v169, v201
    v_mul_f32 v72, v170, v202
    v_mul_f32 v73, v171, v203
    v_add_f32 v66, 1.0, v66
    v_add_f32 v67, 1.0, v67
    v_add_f32 v68, 1.0, v68
    v_add_f32 v69, 1.0, v69
    v_rcp_f32 v66, v66
    v_rcp_f32 v67, v67
    v_rcp_f32 v68, v68
    v_rcp_f32 v69, v69
    v_mul_f32 v70, v70, v66
    v_mul_f32 v71, v71, v67
    v_mul_f32 v72, v72, v68
    v_mul_f32 v73, v73, v69
    v_cvt_pk_bf16_f32 v80, v70, v71
    v_cvt_pk_bf16_f32 v81, v72, v73
    v_mul_f32 v66, v172, v172
    v_mul_f32 v67, v173, v173
    v_mul_f32 v68, v174, v174
    v_mul_f32 v69, v175, v175
    v_fmamk_f32 v66, v66, 0xbdd2d3e8, v64
    v_fmamk_f32 v67, v67, 0xbdd2d3e8, v64
    v_fmamk_f32 v68, v68, 0xbdd2d3e8, v64
    v_fmamk_f32 v69, v69, 0xbdd2d3e8, v64
    v_mul_f32 v66, v66, v172
    v_mul_f32 v67, v67, v173
    v_mul_f32 v68, v68, v174
    v_mul_f32 v69, v69, v175
    v_exp_f32 v66, v66
    v_exp_f32 v67, v67
    v_exp_f32 v68, v68
    v_exp_f32 v69, v69
    v_mul_f32 v70, v172, v204
    v_mul_f32 v71, v173, v205
    v_mul_f32 v72, v174, v206
    v_mul_f32 v73, v175, v207
    v_add_f32 v66, 1.0, v66
    v_add_f32 v67, 1.0, v67
    v_add_f32 v68, 1.0, v68
    v_add_f32 v69, 1.0, v69
    v_rcp_f32 v66, v66
    v_rcp_f32 v67, v67
    v_rcp_f32 v68, v68
    v_rcp_f32 v69, v69
    v_mul_f32 v70, v70, v66
    v_mul_f32 v71, v71, v67
    v_mul_f32 v72, v72, v68
    v_mul_f32 v73, v73, v69
    v_cvt_pk_bf16_f32 v82, v70, v71
    v_cvt_pk_bf16_f32 v83, v72, v73
    buffer_store_dwordx4 v[76:79], v65, s[20:23], s84 offen sc0 sc1
    buffer_store_dwordx4 v[80:83], v65, s[20:23], s84 offen offset:1024 sc0 sc1
    v_mul_f32 v66, v176, v176
    v_mul_f32 v67, v177, v177
    v_mul_f32 v68, v178, v178
    v_mul_f32 v69, v179, v179
    v_fmamk_f32 v66, v66, 0xbdd2d3e8, v64
    v_fmamk_f32 v67, v67, 0xbdd2d3e8, v64
    v_fmamk_f32 v68, v68, 0xbdd2d3e8, v64
    v_fmamk_f32 v69, v69, 0xbdd2d3e8, v64
    v_mul_f32 v66, v66, v176
    v_mul_f32 v67, v67, v177
    v_mul_f32 v68, v68, v178
    v_mul_f32 v69, v69, v179
    v_exp_f32 v66, v66
    v_exp_f32 v67, v67
    v_exp_f32 v68, v68
    v_exp_f32 v69, v69
    v_mul_f32 v70, v176, v208
    v_mul_f32 v71, v177, v209
    v_mul_f32 v72, v178, v210
    v_mul_f32 v73, v179, v211
    v_add_f32 v66, 1.0, v66
    v_add_f32 v67, 1.0, v67
    v_add_f32 v68, 1.0, v68
    v_add_f32 v69, 1.0, v69
    v_rcp_f32 v66, v66
    v_rcp_f32 v67, v67
    v_rcp_f32 v68, v68
    v_rcp_f32 v69, v69
    v_mul_f32 v70, v70, v66
    v_mul_f32 v71, v71, v67
    v_mul_f32 v72, v72, v68
    v_mul_f32 v73, v73, v69
    v_cvt_pk_bf16_f32 v84, v70, v71
    v_cvt_pk_bf16_f32 v85, v72, v73
    v_mul_f32 v66, v180, v180
    v_mul_f32 v67, v181, v181
    v_mul_f32 v68, v182, v182
    v_mul_f32 v69, v183, v183
    v_fmamk_f32 v66, v66, 0xbdd2d3e8, v64
    v_fmamk_f32 v67, v67, 0xbdd2d3e8, v64
    v_fmamk_f32 v68, v68, 0xbdd2d3e8, v64
    v_fmamk_f32 v69, v69, 0xbdd2d3e8, v64
    v_mul_f32 v66, v66, v180
    v_mul_f32 v67, v67, v181
    v_mul_f32 v68, v68, v182
    v_mul_f32 v69, v69, v183
    v_exp_f32 v66, v66
    v_exp_f32 v67, v67
    v_exp_f32 v68, v68
    v_exp_f32 v69, v69
    v_mul_f32 v70, v180, v212
    v_mul_f32 v71, v181, v213
    v_mul_f32 v72, v182, v214
    v_mul_f32 v73, v183, v215
    v_add_f32 v66, 1.0, v66
    v_add_f32 v67, 1.0, v67
    v_add_f32 v68, 1.0, v68
    v_add_f32 v69, 1.0, v69
    v_rcp_f32 v66, v66
    v_rcp_f32 v67, v67
    v_rcp_f32 v68, v68
    v_rcp_f32 v69, v69
    v_mul_f32 v70, v70, v66
    v_mul_f32 v71, v71, v67
    v_mul_f32 v72, v72, v68
    v_mul_f32 v73, v73, v69
    v_cvt_pk_bf16_f32 v86, v70, v71
    v_cvt_pk_bf16_f32 v87, v72, v73
    v_mul_f32 v66, v184, v184
    v_mul_f32 v67, v185, v185
    v_mul_f32 v68, v186, v186
    v_mul_f32 v69, v187, v187
    v_fmamk_f32 v66, v66, 0xbdd2d3e8, v64
    v_fmamk_f32 v67, v67, 0xbdd2d3e8, v64
    v_fmamk_f32 v68, v68, 0xbdd2d3e8, v64
    v_fmamk_f32 v69, v69, 0xbdd2d3e8, v64
    v_mul_f32 v66, v66, v184
    v_mul_f32 v67, v67, v185
    v_mul_f32 v68, v68, v186
    v_mul_f32 v69, v69, v187
    v_exp_f32 v66, v66
    v_exp_f32 v67, v67
    v_exp_f32 v68, v68
    v_exp_f32 v69, v69
    v_mul_f32 v70, v184, v216
    v_mul_f32 v71, v185, v217
    v_mul_f32 v72, v186, v218
    v_mul_f32 v73, v187, v219
    v_add_f32 v66, 1.0, v66
    v_add_f32 v67, 1.0, v67
    v_add_f32 v68, 1.0, v68
    v_add_f32 v69, 1.0, v69
    v_rcp_f32 v66, v66
    v_rcp_f32 v67, v67
    v_rcp_f32 v68, v68
    v_rcp_f32 v69, v69
    v_mul_f32 v70, v70, v66
    v_mul_f32 v71, v71, v67
    v_mul_f32 v72, v72, v68
    v_mul_f32 v73, v73, v69
    v_cvt_pk_bf16_f32 v88, v70, v71
    v_cvt_pk_bf16_f32 v89, v72, v73
    v_mul_f32 v66, v188, v188
    v_mul_f32 v67, v189, v189
    v_mul_f32 v68, v190, v190
    v_mul_f32 v69, v191, v191
    v_fmamk_f32 v66, v66, 0xbdd2d3e8, v64
    v_fmamk_f32 v67, v67, 0xbdd2d3e8, v64
    v_fmamk_f32 v68, v68, 0xbdd2d3e8, v64
    v_fmamk_f32 v69, v69, 0xbdd2d3e8, v64
    v_mul_f32 v66, v66, v188
    v_mul_f32 v67, v67, v189
    v_mul_f32 v68, v68, v190
    v_mul_f32 v69, v69, v191
    v_exp_f32 v66, v66
    v_exp_f32 v67, v67
    v_exp_f32 v68, v68
    v_exp_f32 v69, v69
    v_mul_f32 v70, v188, v220
    v_mul_f32 v71, v189, v221
    v_mul_f32 v72, v190, v222
    v_mul_f32 v73, v191, v223
    v_add_f32 v66, 1.0, v66
    v_add_f32 v67, 1.0, v67
    v_add_f32 v68, 1.0, v68
    v_add_f32 v69, 1.0, v69
    v_rcp_f32 v66, v66
    v_rcp_f32 v67, v67
    v_rcp_f32 v68, v68
    v_rcp_f32 v69, v69
    v_mul_f32 v70, v70, v66
    v_mul_f32 v71, v71, v67
    v_mul_f32 v72, v72, v68
    v_mul_f32 v73, v73, v69
    v_cvt_pk_bf16_f32 v90, v70, v71
    v_cvt_pk_bf16_f32 v91, v72, v73
    buffer_store_dwordx4 v[84:87], v65, s[20:23], s85 offen sc0 sc1
    buffer_store_dwordx4 v[88:91], v65, s[20:23], s85 offen offset:1024 sc0 sc1
    s_endpgm
K1_DFT:
    s_sub_u32 s72, s2, 224
    s_lshr_b32 s73, s72, 3
    s_and_b32 s75, s73, 1
    s_lshr_b32 s73, s73, 1
    s_and_b32 s74, s72, 1
    s_lshl_b32 s74, s74, 3
    s_add_u32 s74, s74, s73
    s_lshr_b32 s73, s72, 1
    s_and_b32 s73, s73, 3
    s_lshl_b32 s73, s73, 1
    s_add_u32 s74, s74, s73
    s_lshl_b32 s76, s74, 2
    s_lshr_b32 s77, s36, 1
    s_add_u32 s76, s76, s77
    s_mul_i32 s76, s76, 896
    s_and_b32 s77, s36, 1
    s_mul_i32 s77, s77, 917504
    s_add_u32 s76, s76, s77
    v_lshrrev_b32 v8, 3, v1
    v_mul_u32_u24 v9, 57344, v8
    v_add_u32 v9, s76, v9
    v_lshrrev_b32 v10, 4, v1
    v_and_b32 v11, 7, v1
    v_xor_b32 v12, v11, v10
    v_xor_b32 v13, 4, v12
    v_lshl_add_u32 v4, v12, 4, v9
    v_lshl_add_u32 v5, v13, 4, v9
    v_add_u32 v5, 458752, v5
    s_lshl_b32 s78, s36, 11
    s_mov_b32 s80, 0
    s_add_u32 m0, s78, 0
    s_nop 0
    buffer_load_dwordx4 v4, s[8:11], s80 offen lds
    s_add_u32 m0, s78, 1024
    s_nop 0
    buffer_load_dwordx4 v5, s[8:11], s80 offen lds
    s_and_b32 s40, s2, 31
    s_lshr_b32 s41, s2, 5
    s_lshl_b32 s41, s41, 3
    v_and_b32 v116, 255, v0
    v_lshrrev_b32 v117, 8, v0
    v_lshlrev_b32 v117, 2, v117
    v_add_u32 v117, s41, v117
    v_lshlrev_b32 v118, 5, v117
    v_add_u32 v118, s40, v118
    v_mul_u32_u24 v118, 450, v118
    v_lshl_add_u32 v118, v116, 1, v118
    s_mov_b32 s42, 14400
    s_mov_b32 s43, 28800
    s_mov_b32 s44, 43200
    buffer_load_ushort v100, v118, s[24:27], 0 offen
    buffer_load_ushort v101, v118, s[24:27], s42 offen
    buffer_load_ushort v102, v118, s[24:27], s43 offen
    buffer_load_ushort v103, v118, s[24:27], s44 offen
    buffer_load_ushort v104, v118, s[28:31], 0 offen
    buffer_load_ushort v105, v118, s[28:31], s42 offen
    buffer_load_ushort v106, v118, s[28:31], s43 offen
    buffer_load_ushort v107, v118, s[28:31], s44 offen
    v_lshlrev_b32 v118, 5, v116
    v_add_u32 v118, s40, v118
    v_lshl_add_u32 v118, v118, 6, v117
    v_lshlrev_b32 v118, 2, v118
    v_add_u32 v118, 0x900000, v118
    s_lshl_b32 s45, s2, 3
    s_add_u32 s45, s45, s36
    s_mul_i32 s46, s45, 896
    v_lshlrev_b32 v119, 4, v1
    v_add_u32 v120, s46, v119
    v_mov_b32 v121, 0x7ffffff0
    v_cmp_gt_u32 vcc, 56, v1
    s_nop 1
    v_cndmask_b32 v120, v121, v120, vcc
    buffer_load_dwordx4 v[108:111], v120, s[8:11], 0 offen
    buffer_load_dwordx4 v[112:115], v119, s[32:35], 0 offen
    v_and_b32 v8, 31, v1
    v_lshlrev_b32 v8, 7, v8
    v_lshrrev_b32 v9, 5, v1
    v_lshrrev_b32 v10, 1, v1
    v_and_b32 v10, 7, v10
    v_add_u32 v11, 0, v9
    v_xor_b32 v11, v11, v10
    v_lshl_add_u32 v14, v11, 4, v8
    v_add_u32 v18, 65536, v14
    v_add_u32 v11, 2, v9
    v_xor_b32 v11, v11, v10
    v_lshl_add_u32 v15, v11, 4, v8
    v_add_u32 v19, 65536, v15
    v_add_u32 v11, 4, v9
    v_xor_b32 v11, v11, v10
    v_lshl_add_u32 v16, v11, 4, v8
    v_add_u32 v20, 65536, v16
    v_add_u32 v11, 6, v9
    v_xor_b32 v11, v11, v10
    v_lshl_add_u32 v17, v11, 4, v8
    v_add_u32 v21, 65536, v17
    s_lshl_b32 s82, s75, 7
    s_lshl_b32 s83, s36, 4
    s_add_u32 s82, s82, s83
    v_and_b32 v8, 15, v1
    v_add_u32 v22, s82, v8
    v_cvt_f32_u32 v23, v22
    v_mul_f32 v23, 0x3b124925, v23
    v_lshrrev_b32 v9, 5, v1
    v_lshlrev_b32 v9, 3, v9
    v_cvt_f32_u32 v9, v9
    v_lshrrev_b32 v10, 4, v1
    v_and_b32 v10, 1, v10
    v_cvt_f32_u32 v11, v10
    v_mul_f32 v11, 0.5, v11
    v_mul_f32 v11, 0.5, v11
    v_fma_f32 v24, v9, v23, v11
    v_and_b32 v9, 31, v1
    v_and_b32 v11, 15, v9
    v_lshrrev_b32 v9, 4, v9
    v_lshl_add_u32 v9, v11, 1, v9
    v_mul_u32_u24 v25, 272, v9
    v_lshrrev_b32 v9, 5, v1
    v_lshl_add_u32 v25, v9, 4, v25
    s_mul_i32 s85, s36, 8704
    v_add_u32 v25, s85, v25
    v_lshrrev_b32 v9, 4, v1
    v_mul_u32_u24 v26, 272, v9
    v_lshl_add_u32 v26, v8, 4, v26
    v_add_u32 v26, s85, v26
    v_lshlrev_b32 v27, 12, v9
    v_lshl_add_u32 v27, v8, 4, v27
    s_lshl_b32 s84, s82, 13
    s_lshl_b32 s85, s74, 8
    s_add_u32 s84, s84, s85
    s_add_u32 s84, s84, 0x700000
    v_cos_f32 v28, v23
    s_nop 0
    v_add_f32 v28, v28, v28
    v_mov_b32 v160, 0
    v_mov_b32 v161, 0
    v_mov_b32 v162, 0
    v_mov_b32 v163, 0
    v_mov_b32 v164, 0
    v_mov_b32 v165, 0
    v_mov_b32 v166, 0
    v_mov_b32 v167, 0
    v_mov_b32 v168, 0
    v_mov_b32 v169, 0
    v_mov_b32 v170, 0
    v_mov_b32 v171, 0
    v_mov_b32 v172, 0
    v_mov_b32 v173, 0
    v_mov_b32 v174, 0
    v_mov_b32 v175, 0
    v_mov_b32 v176, 0
    v_mov_b32 v177, 0
    v_mov_b32 v178, 0
    v_mov_b32 v179, 0
    v_mov_b32 v180, 0
    v_mov_b32 v181, 0
    v_mov_b32 v182, 0
    v_mov_b32 v183, 0
    v_mov_b32 v184, 0
    v_mov_b32 v185, 0
    v_mov_b32 v186, 0
    v_mov_b32 v187, 0
    v_mov_b32 v188, 0
    v_mov_b32 v189, 0
    v_mov_b32 v190, 0
    v_mov_b32 v191, 0
    v_mov_b32 v192, 0
    v_mov_b32 v193, 0
    v_mov_b32 v194, 0
    v_mov_b32 v195, 0
    v_mov_b32 v196, 0
    v_mov_b32 v197, 0
    v_mov_b32 v198, 0
    v_mov_b32 v199, 0
    v_mov_b32 v200, 0
    v_mov_b32 v201, 0
    v_mov_b32 v202, 0
    v_mov_b32 v203, 0
    v_mov_b32 v204, 0
    v_mov_b32 v205, 0
    v_mov_b32 v206, 0
    v_mov_b32 v207, 0
    v_mov_b32 v208, 0
    v_mov_b32 v209, 0
    v_mov_b32 v210, 0
    v_mov_b32 v211, 0
    v_mov_b32 v212, 0
    v_mov_b32 v213, 0
    v_mov_b32 v214, 0
    v_mov_b32 v215, 0
    v_mov_b32 v216, 0
    v_mov_b32 v217, 0
    v_mov_b32 v218, 0
    v_mov_b32 v219, 0
    v_mov_b32 v220, 0
    v_mov_b32 v221, 0
    v_mov_b32 v222, 0
    v_mov_b32 v223, 0
    s_mov_b32 s53, 0x7ffffff0
    s_cmp_ge_u32 s45, 38
    s_cbranch_scc1 TJ2_E
    s_lshl_b32 s53, s45, 10
    s_add_u32 s53, s53, 0xb80000
    s_cmp_ge_u32 s45, 22
    s_cbranch_scc1 TJ2_F
    v_and_b32 v129, 31, v1
    v_lshrrev_b32 v130, 5, v1
    s_mov_b32 s48, s45
    s_cmp_ge_u32 s48, 6
    s_cbranch_scc1 TJ2_X
    s_mov_b32 s52, 0x3d000000
    s_mov_b32 s47, 0
    s_and_b32 s49, s48, 1
    s_lshl_b32 s49, s49, 4
    s_lshr_b32 s50, s48, 1
    s_cmp_eq_u32 s50, 1
    s_cselect_b32 s51, 0x3e800000, 0
    s_cmp_eq_u32 s50, 2
    s_cselect_b32 s50, 0xbe800000, s51
    s_branch TJ2_C
TJ2_X:
    s_sub_u32 s48, s48, 6
    s_mov_b32 s52, 0x3c800000
    s_lshr_b32 s47, s48, 2
    s_and_b32 s47, s47, 1
    s_lshl_b32 s47, s47, 5
    s_and_b32 s49, s48, 3
    s_lshl_b32 s49, s49, 4
    s_cmp_ge_u32 s48, 8
    s_cselect_b32 s50, 0x3e800000, 0
TJ2_C:
    v_add_u32 v129, s47, v129
    v_cvt_f32_u32 v129, v129
    v_mul_f32 v129, s52, v129
    v_lshlrev_b32 v130, 2, v130
    v_add_u32 v130, s49, v130
    v_cvt_f32_u32 v130, v130
    v_mov_b32 v131, s50
    v_add_f32 v144, 0x00000000, v130
    v_fma_f32 v136, v144, v129, v131
    v_cos_f32 v136, v136
    v_add_f32 v144, 0x3f800000, v130
    v_fma_f32 v137, v144, v129, v131
    v_cos_f32 v137, v137
    v_add_f32 v144, 0x40000000, v130
    v_fma_f32 v138, v144, v129, v131
    v_cos_f32 v138, v138
    v_add_f32 v144, 0x40400000, v130
    v_fma_f32 v139, v144, v129, v131
    v_cos_f32 v139, v139
    v_add_f32 v144, 0x41000000, v130
    v_fma_f32 v140, v144, v129, v131
    v_cos_f32 v140, v140
    v_add_f32 v144, 0x41100000, v130
    v_fma_f32 v141, v144, v129, v131
    v_cos_f32 v141, v141
    v_add_f32 v144, 0x41200000, v130
    v_fma_f32 v142, v144, v129, v131
    v_cos_f32 v142, v142
    v_add_f32 v144, 0x41300000, v130
    v_fma_f32 v143, v144, v129, v131
    v_cos_f32 v143, v143
    v_cvt_pk_bf16_f32 v124, v136, v137
    v_cvt_pk_bf16_f32 v125, v138, v139
    v_cvt_pk_bf16_f32 v126, v140, v141
    v_cvt_pk_bf16_f32 v127, v142, v143
    s_branch TJ2_E
TJ2_F:
    s_sub_u32 s48, s45, 22
    s_lshl_b32 s48, s48, 4
    v_lshrrev_b32 v144, 2, v1
    v_add_u32 v144, s48, v144
    v_cmp_lt_u32 vcc, 224, v144
    s_nop 1
    v_cndmask_b32 v124, 0, 1, vcc
TJ2_E:
    v_lshlrev_b32 v128, 4, v1
    v_add_u32 v128, s53, v128
    s_mov_b32 s80, 128
    s_add_u32 m0, s78, 16384
    s_nop 0
    buffer_load_dwordx4 v4, s[8:11], s80 offen lds
    s_add_u32 m0, s78, 17408
    s_nop 0
    buffer_load_dwordx4 v5, s[8:11], s80 offen lds
    s_mov_b32 s80, 256
    s_add_u32 m0, s78, 32768
    s_nop 0
    buffer_load_dwordx4 v4, s[8:11], s80 offen lds
    s_add_u32 m0, s78, 33792
    s_nop 0
    buffer_load_dwordx4 v5, s[8:11], s80 offen lds
    s_waitcnt vmcnt(4)
    v_lshl_or_b32 v100, v104, 16, v100
    v_lshl_or_b32 v101, v105, 16, v101
    v_lshl_or_b32 v102, v106, 16, v102
    v_lshl_or_b32 v103, v107, 16, v103
    v_mov_b32 v136, 0
    v_lshlrev_b32 v137, 16, v108
    v_lshlrev_b32 v138, 16, v112
    v_fmac_f32 v136, v137, v138
    v_and_b32 v137, 0xffff0000, v108
    v_and_b32 v138, 0xffff0000, v112
    v_fmac_f32 v136, v137, v138
    v_lshlrev_b32 v137, 16, v109
    v_lshlrev_b32 v138, 16, v113
    v_fmac_f32 v136, v137, v138
    v_and_b32 v137, 0xffff0000, v109
    v_and_b32 v138, 0xffff0000, v113
    v_fmac_f32 v136, v137, v138
    v_lshlrev_b32 v137, 16, v110
    v_lshlrev_b32 v138, 16, v114
    v_fmac_f32 v136, v137, v138
    v_and_b32 v137, 0xffff0000, v110
    v_and_b32 v138, 0xffff0000, v114
    v_fmac_f32 v136, v137, v138
    v_lshlrev_b32 v137, 16, v111
    v_lshlrev_b32 v138, 16, v115
    v_fmac_f32 v136, v137, v138
    v_and_b32 v137, 0xffff0000, v111
    v_and_b32 v138, 0xffff0000, v115
    v_fmac_f32 v136, v137, v138
    s_nop 1
    v_add_f32_dpp v136, v136, v136 row_shr:1 row_mask:0xf bank_mask:0xf bound_ctrl:0
    s_nop 1
    v_add_f32_dpp v136, v136, v136 row_shr:2 row_mask:0xf bank_mask:0xf bound_ctrl:0
    s_nop 1
    v_add_f32_dpp v136, v136, v136 row_shr:4 row_mask:0xf bank_mask:0xf bound_ctrl:0
    s_nop 1
    v_add_f32_dpp v136, v136, v136 row_shr:8 row_mask:0xf bank_mask:0xf bound_ctrl:0
    s_nop 0
    v_readlane_b32 s54, v136, 15
    v_readlane_b32 s55, v136, 31
    v_readlane_b32 s56, v136, 47
    v_readlane_b32 s57, v136, 63
    v_mov_b32 v136, s54
    v_add_f32 v136, s55, v136
    v_add_f32 v136, s56, v136
    v_add_f32 v136, s57, v136
    v_mul_f32 v136, 0xbfb8aa3b, v136
    v_exp_f32 v136, v136
    s_nop 0
    v_add_f32 v136, 1.0, v136
    v_rcp_f32 v136, v136
    s_and_b32 s54, s45, 63
    s_lshl_b32 s54, s54, 5
    s_lshr_b32 s55, s45, 6
    s_add_u32 s54, s54, s55
    s_lshl_b32 s54, s54, 2
    s_add_u32 s54, s54, 0xb00000
    v_mov_b32 v137, s54
    buffer_store_dwordx4 v[124:127], v128, s[20:23], 0 offen sc0 sc1
    v_cmp_gt_u32 vcc, 225, v116
    s_nop 1
    s_and_saveexec_b64 s[58:59], vcc
    buffer_store_dwordx4 v[100:103], v118, s[20:23], 0 offen sc0 sc1
    s_mov_b64 exec, 1
    buffer_store_dword v136, v137, s[20:23], 0 offen
    s_mov_b64 exec, s[58:59]
    v_fmamk_f32 v72, v23, 0x00000000, v24
    v_fmamk_f32 v73, v23, 0x3f800000, v24
    v_cos_f32 v72, v72
    v_cos_f32 v73, v73
    s_nop 0
    v_fma_f32 v74, v28, v73, -v72
    v_fma_f32 v75, v28, v74, -v73
    v_fma_f32 v76, v28, v75, -v74
    v_fma_f32 v77, v28, v76, -v75
    v_fma_f32 v78, v28, v77, -v76
    v_fma_f32 v79, v28, v78, -v77
    v_cvt_pk_bf16_f32 v64, v72, v73
    v_cvt_pk_bf16_f32 v65, v74, v75
    v_cvt_pk_bf16_f32 v66, v76, v77
    v_cvt_pk_bf16_f32 v67, v78, v79
    s_waitcnt vmcnt(7)
    s_barrier
    ds_read_b128 v[32:35], v14 offset:0
    ds_read_b128 v[36:39], v14 offset:4096
    ds_read_b128 v[40:43], v14 offset:8192
    ds_read_b128 v[44:47], v14 offset:12288
    ds_read_b128 v[48:51], v15 offset:0
    ds_read_b128 v[52:55], v15 offset:4096
    ds_read_b128 v[56:59], v15 offset:8192
    ds_read_b128 v[60:63], v15 offset:12288
    s_waitcnt lgkmcnt(4)
    v_mfma_f32_32x32x16_bf16 v[160:175], v[32:35], v[64:67], v[160:175]
    v_mfma_f32_32x32x16_bf16 v[176:191], v[36:39], v[64:67], v[176:191]
    v_mfma_f32_32x32x16_bf16 v[192:207], v[40:43], v[64:67], v[192:207]
    v_mfma_f32_32x32x16_bf16 v[208:223], v[44:47], v[64:67], v[208:223]
    v_fmamk_f32 v72, v23, 0x41800000, v24
    v_fmamk_f32 v73, v23, 0x41880000, v24
    v_cos_f32 v72, v72
    v_cos_f32 v73, v73
    s_nop 0
    v_fma_f32 v74, v28, v73, -v72
    v_fma_f32 v75, v28, v74, -v73
    v_fma_f32 v76, v28, v75, -v74
    v_fma_f32 v77, v28, v76, -v75
    v_fma_f32 v78, v28, v77, -v76
    v_fma_f32 v79, v28, v78, -v77
    v_cvt_pk_bf16_f32 v68, v72, v73
    v_cvt_pk_bf16_f32 v69, v74, v75
    v_cvt_pk_bf16_f32 v70, v76, v77
    v_cvt_pk_bf16_f32 v71, v78, v79
    s_mov_b32 s80, 384
    s_add_u32 m0, s78, 49152
    s_nop 0
    buffer_load_dwordx4 v4, s[8:11], s80 offen lds
    s_add_u32 m0, s78, 50176
    s_nop 0
    buffer_load_dwordx4 v5, s[8:11], s80 offen lds
    ds_read_b128 v[32:35], v16 offset:0
    ds_read_b128 v[36:39], v16 offset:4096
    ds_read_b128 v[40:43], v16 offset:8192
    ds_read_b128 v[44:47], v16 offset:12288
    s_waitcnt lgkmcnt(4)
    v_mfma_f32_32x32x16_bf16 v[160:175], v[48:51], v[68:71], v[160:175]
    v_mfma_f32_32x32x16_bf16 v[176:191], v[52:55], v[68:71], v[176:191]
    v_mfma_f32_32x32x16_bf16 v[192:207], v[56:59], v[68:71], v[192:207]
    v_mfma_f32_32x32x16_bf16 v[208:223], v[60:63], v[68:71], v[208:223]
    v_fmamk_f32 v72, v23, 0x42000000, v24
    v_fmamk_f32 v73, v23, 0x42040000, v24
    v_cos_f32 v72, v72
    v_cos_f32 v73, v73
    s_nop 0
    v_fma_f32 v74, v28, v73, -v72
    v_fma_f32 v75, v28, v74, -v73
    v_fma_f32 v76, v28, v75, -v74
    v_fma_f32 v77, v28, v76, -v75
    v_fma_f32 v78, v28, v77, -v76
    v_fma_f32 v79, v28, v78, -v77
    v_cvt_pk_bf16_f32 v64, v72, v73
    v_cvt_pk_bf16_f32 v65, v74, v75
    v_cvt_pk_bf16_f32 v66, v76, v77
    v_cvt_pk_bf16_f32 v67, v78, v79
    ds_read_b128 v[48:51], v17 offset:0
    ds_read_b128 v[52:55], v17 offset:4096
    ds_read_b128 v[56:59], v17 offset:8192
    ds_read_b128 v[60:63], v17 offset:12288
    s_waitcnt lgkmcnt(4)
    v_mfma_f32_32x32x16_bf16 v[160:175], v[32:35], v[64:67], v[160:175]
    v_mfma_f32_32x32x16_bf16 v[176:191], v[36:39], v[64:67], v[176:191]
    v_mfma_f32_32x32x16_bf16 v[192:207], v[40:43], v[64:67], v[192:207]
    v_mfma_f32_32x32x16_bf16 v[208:223], v[44:47], v[64:67], v[208:223]
    v_fmamk_f32 v72, v23, 0x42400000, v24
    v_fmamk_f32 v73, v23, 0x42440000, v24
    v_cos_f32 v72, v72
    v_cos_f32 v73, v73
    s_nop 0
    v_fma_f32 v74, v28, v73, -v72
    v_fma_f32 v75, v28, v74, -v73
    v_fma_f32 v76, v28, v75, -v74
    v_fma_f32 v77, v28, v76, -v75
    v_fma_f32 v78, v28, v77, -v76
    v_fma_f32 v79, v28, v78, -v77
    v_cvt_pk_bf16_f32 v68, v72, v73
    v_cvt_pk_bf16_f32 v69, v74, v75
    v_cvt_pk_bf16_f32 v70, v76, v77
    v_cvt_pk_bf16_f32 v71, v78, v79
    s_waitcnt vmcnt(7)
    s_barrier
    ds_read_b128 v[32:35], v14 offset:16384
    ds_read_b128 v[36:39], v14 offset:20480
    ds_read_b128 v[40:43], v14 offset:24576
    ds_read_b128 v[44:47], v14 offset:28672
    s_waitcnt lgkmcnt(4)
    v_mfma_f32_32x32x16_bf16 v[160:175], v[48:51], v[68:71], v[160:175]
    v_mfma_f32_32x32x16_bf16 v[176:191], v[52:55], v[68:71], v[176:191]
    v_mfma_f32_32x32x16_bf16 v[192:207], v[56:59], v[68:71], v[192:207]
    v_mfma_f32_32x32x16_bf16 v[208:223], v[60:63], v[68:71], v[208:223]
    v_fmamk_f32 v72, v23, 0x42800000, v24
    v_fmamk_f32 v73, v23, 0x42820000, v24
    v_cos_f32 v72, v72
    v_cos_f32 v73, v73
    s_nop 0
    v_fma_f32 v74, v28, v73, -v72
    v_fma_f32 v75, v28, v74, -v73
    v_fma_f32 v76, v28, v75, -v74
    v_fma_f32 v77, v28, v76, -v75
    v_fma_f32 v78, v28, v77, -v76
    v_fma_f32 v79, v28, v78, -v77
    v_cvt_pk_bf16_f32 v64, v72, v73
    v_cvt_pk_bf16_f32 v65, v74, v75
    v_cvt_pk_bf16_f32 v66, v76, v77
    v_cvt_pk_bf16_f32 v67, v78, v79
    ds_read_b128 v[48:51], v15 offset:16384
    ds_read_b128 v[52:55], v15 offset:20480
    ds_read_b128 v[56:59], v15 offset:24576
    ds_read_b128 v[60:63], v15 offset:28672
    s_waitcnt lgkmcnt(4)
    v_mfma_f32_32x32x16_bf16 v[160:175], v[32:35], v[64:67], v[160:175]
    v_mfma_f32_32x32x16_bf16 v[176:191], v[36:39], v[64:67], v[176:191]
    v_mfma_f32_32x32x16_bf16 v[192:207], v[40:43], v[64:67], v[192:207]
    v_mfma_f32_32x32x16_bf16 v[208:223], v[44:47], v[64:67], v[208:223]
    v_fmamk_f32 v72, v23, 0x42a00000, v24
    v_fmamk_f32 v73, v23, 0x42a20000, v24
    v_cos_f32 v72, v72
    v_cos_f32 v73, v73
    s_nop 0
    v_fma_f32 v74, v28, v73, -v72
    v_fma_f32 v75, v28, v74, -v73
    v_fma_f32 v76, v28, v75, -v74
    v_fma_f32 v77, v28, v76, -v75
    v_fma_f32 v78, v28, v77, -v76
    v_fma_f32 v79, v28, v78, -v77
    v_cvt_pk_bf16_f32 v68, v72, v73
    v_cvt_pk_bf16_f32 v69, v74, v75
    v_cvt_pk_bf16_f32 v70, v76, v77
    v_cvt_pk_bf16_f32 v71, v78, v79
    s_mov_b32 s80, 512
    s_add_u32 m0, s78, 65536
    s_nop 0
    buffer_load_dwordx4 v4, s[8:11], s80 offen lds
    s_add_u32 m0, s78, 66560
    s_nop 0
    buffer_load_dwordx4 v5, s[8:11], s80 offen lds
    ds_read_b128 v[32:35], v16 offset:16384
    ds_read_b128 v[36:39], v16 offset:20480
    ds_read_b128 v[40:43], v16 offset:24576
    ds_read_b128 v[44:47], v16 offset:28672
    s_waitcnt lgkmcnt(4)
    v_mfma_f32_32x32x16_bf16 v[160:175], v[48:51], v[68:71], v[160:175]
    v_mfma_f32_32x32x16_bf16 v[176:191], v[52:55], v[68:71], v[176:191]
    v_mfma_f32_32x32x16_bf16 v[192:207], v[56:59], v[68:71], v[192:207]
    v_mfma_f32_32x32x16_bf16 v[208:223], v[60:63], v[68:71], v[208:223]
    v_fmamk_f32 v72, v23, 0x42c00000, v24
    v_fmamk_f32 v73, v23, 0x42c20000, v24
    v_cos_f32 v72, v72
    v_cos_f32 v73, v73
    s_nop 0
    v_fma_f32 v74, v28, v73, -v72
    v_fma_f32 v75, v28, v74, -v73
    v_fma_f32 v76, v28, v75, -v74
    v_fma_f32 v77, v28, v76, -v75
    v_fma_f32 v78, v28, v77, -v76
    v_fma_f32 v79, v28, v78, -v77
    v_cvt_pk_bf16_f32 v64, v72, v73
    v_cvt_pk_bf16_f32 v65, v74, v75
    v_cvt_pk_bf16_f32 v66, v76, v77
    v_cvt_pk_bf16_f32 v67, v78, v79
    ds_read_b128 v[48:51], v17 offset:16384
    ds_read_b128 v[52:55], v17 offset:20480
    ds_read_b128 v[56:59], v17 offset:24576
    ds_read_b128 v[60:63], v17 offset:28672
    s_waitcnt lgkmcnt(4)
    v_mfma_f32_32x32x16_bf16 v[160:175], v[32:35], v[64:67], v[160:175]
    v_mfma_f32_32x32x16_bf16 v[176:191], v[36:39], v[64:67], v[176:191]
    v_mfma_f32_32x32x16_bf16 v[192:207], v[40:43], v[64:67], v[192:207]
    v_mfma_f32_32x32x16_bf16 v[208:223], v[44:47], v[64:67], v[208:223]
    v_fmamk_f32 v72, v23, 0x42e00000, v24
    v_fmamk_f32 v73, v23, 0x42e20000, v24
    v_cos_f32 v72, v72
    v_cos_f32 v73, v73
    s_nop 0
    v_fma_f32 v74, v28, v73, -v72
    v_fma_f32 v75, v28, v74, -v73
    v_fma_f32 v76, v28, v75, -v74
    v_fma_f32 v77, v28, v76, -v75
    v_fma_f32 v78, v28, v77, -v76
    v_fma_f32 v79, v28, v78, -v77
    v_cvt_pk_bf16_f32 v68, v72, v73
    v_cvt_pk_bf16_f32 v69, v74, v75
    v_cvt_pk_bf16_f32 v70, v76, v77
    v_cvt_pk_bf16_f32 v71, v78, v79
    s_waitcnt vmcnt(7)
    s_barrier
    ds_read_b128 v[32:35], v14 offset:32768
    ds_read_b128 v[36:39], v14 offset:36864
    ds_read_b128 v[40:43], v14 offset:40960
    ds_read_b128 v[44:47], v14 offset:45056
    s_waitcnt lgkmcnt(4)
    v_mfma_f32_32x32x16_bf16 v[160:175], v[48:51], v[68:71], v[160:175]
    v_mfma_f32_32x32x16_bf16 v[176:191], v[52:55], v[68:71], v[176:191]
    v_mfma_f32_32x32x16_bf16 v[192:207], v[56:59], v[68:71], v[192:207]
    v_mfma_f32_32x32x16_bf16 v[208:223], v[60:63], v[68:71], v[208:223]
    v_fmamk_f32 v72, v23, 0x43000000, v24
    v_fmamk_f32 v73, v23, 0x43010000, v24
    v_cos_f32 v72, v72
    v_cos_f32 v73, v73
    s_nop 0
    v_fma_f32 v74, v28, v73, -v72
    v_fma_f32 v75, v28, v74, -v73
    v_fma_f32 v76, v28, v75, -v74
    v_fma_f32 v77, v28, v76, -v75
    v_fma_f32 v78, v28, v77, -v76
    v_fma_f32 v79, v28, v78, -v77
    v_cvt_pk_bf16_f32 v64, v72, v73
    v_cvt_pk_bf16_f32 v65, v74, v75
    v_cvt_pk_bf16_f32 v66, v76, v77
    v_cvt_pk_bf16_f32 v67, v78, v79
    ds_read_b128 v[48:51], v15 offset:32768
    ds_read_b128 v[52:55], v15 offset:36864
    ds_read_b128 v[56:59], v15 offset:40960
    ds_read_b128 v[60:63], v15 offset:45056
    s_waitcnt lgkmcnt(4)
    v_mfma_f32_32x32x16_bf16 v[160:175], v[32:35], v[64:67], v[160:175]
    v_mfma_f32_32x32x16_bf16 v[176:191], v[36:39], v[64:67], v[176:191]
    v_mfma_f32_32x32x16_bf16 v[192:207], v[40:43], v[64:67], v[192:207]
    v_mfma_f32_32x32x16_bf16 v[208:223], v[44:47], v[64:67], v[208:223]
    v_fmamk_f32 v72, v23, 0x43100000, v24
    v_fmamk_f32 v73, v23, 0x43110000, v24
    v_cos_f32 v72, v72
    v_cos_f32 v73, v73
    s_nop 0
    v_fma_f32 v74, v28, v73, -v72
    v_fma_f32 v75, v28, v74, -v73
    v_fma_f32 v76, v28, v75, -v74
    v_fma_f32 v77, v28, v76, -v75
    v_fma_f32 v78, v28, v77, -v76
    v_fma_f32 v79, v28, v78, -v77
    v_cvt_pk_bf16_f32 v68, v72, v73
    v_cvt_pk_bf16_f32 v69, v74, v75
    v_cvt_pk_bf16_f32 v70, v76, v77
    v_cvt_pk_bf16_f32 v71, v78, v79
    s_mov_b32 s80, 640
    s_add_u32 m0, s78, 81920
    s_nop 0
    buffer_load_dwordx4 v4, s[8:11], s80 offen lds
    s_add_u32 m0, s78, 82944
    s_nop 0
    buffer_load_dwordx4 v5, s[8:11], s80 offen lds
    ds_read_b128 v[32:35], v16 offset:32768
    ds_read_b128 v[36:39], v16 offset:36864
    ds_read_b128 v[40:43], v16 offset:40960
    ds_read_b128 v[44:47], v16 offset:45056
    s_waitcnt lgkmcnt(4)
    v_mfma_f32_32x32x16_bf16 v[160:175], v[48:51], v[68:71], v[160:175]
    v_mfma_f32_32x32x16_bf16 v[176:191], v[52:55], v[68:71], v[176:191]
    v_mfma_f32_32x32x16_bf16 v[192:207], v[56:59], v[68:71], v[192:207]
    v_mfma_f32_32x32x16_bf16 v[208:223], v[60:63], v[68:71], v[208:223]
    v_fmamk_f32 v72, v23, 0x43200000, v24
    v_fmamk_f32 v73, v23, 0x43210000, v24
    v_cos_f32 v72, v72
    v_cos_f32 v73, v73
    s_nop 0
    v_fma_f32 v74, v28, v73, -v72
    v_fma_f32 v75, v28, v74, -v73
    v_fma_f32 v76, v28, v75, -v74
    v_fma_f32 v77, v28, v76, -v75
    v_fma_f32 v78, v28, v77, -v76
    v_fma_f32 v79, v28, v78, -v77
    v_cvt_pk_bf16_f32 v64, v72, v73
    v_cvt_pk_bf16_f32 v65, v74, v75
    v_cvt_pk_bf16_f32 v66, v76, v77
    v_cvt_pk_bf16_f32 v67, v78, v79
    ds_read_b128 v[48:51], v17 offset:32768
    ds_read_b128 v[52:55], v17 offset:36864
    ds_read_b128 v[56:59], v17 offset:40960
    ds_read_b128 v[60:63], v17 offset:45056
    s_waitcnt lgkmcnt(4)
    v_mfma_f32_32x32x16_bf16 v[160:175], v[32:35], v[64:67], v[160:175]
    v_mfma_f32_32x32x16_bf16 v[176:191], v[36:39], v[64:67], v[176:191]
    v_mfma_f32_32x32x16_bf16 v[192:207], v[40:43], v[64:67], v[192:207]
    v_mfma_f32_32x32x16_bf16 v[208:223], v[44:47], v[64:67], v[208:223]
    v_fmamk_f32 v72, v23, 0x43300000, v24
    v_fmamk_f32 v73, v23, 0x43310000, v24
    v_cos_f32 v72, v72
    v_cos_f32 v73, v73
    s_nop 0
    v_fma_f32 v74, v28, v73, -v72
    v_fma_f32 v75, v28, v74, -v73
    v_fma_f32 v76, v28, v75, -v74
    v_fma_f32 v77, v28, v76, -v75
    v_fma_f32 v78, v28, v77, -v76
    v_fma_f32 v79, v28, v78, -v77
    v_cvt_pk_bf16_f32 v68, v72, v73
    v_cvt_pk_bf16_f32 v69, v74, v75
    v_cvt_pk_bf16_f32 v70, v76, v77
    v_cvt_pk_bf16_f32 v71, v78, v79
    s_waitcnt vmcnt(4)
    s_barrier
    ds_read_b128 v[32:35], v14 offset:49152
    ds_read_b128 v[36:39], v14 offset:53248
    ds_read_b128 v[40:43], v14 offset:57344
    ds_read_b128 v[44:47], v14 offset:61440
    s_waitcnt lgkmcnt(4)
    v_mfma_f32_32x32x16_bf16 v[160:175], v[48:51], v[68:71], v[160:175]
    v_mfma_f32_32x32x16_bf16 v[176:191], v[52:55], v[68:71], v[176:191]
    v_mfma_f32_32x32x16_bf16 v[192:207], v[56:59], v[68:71], v[192:207]
    v_mfma_f32_32x32x16_bf16 v[208:223], v[60:63], v[68:71], v[208:223]
    v_fmamk_f32 v72, v23, 0x43400000, v24
    v_fmamk_f32 v73, v23, 0x43410000, v24
    v_cos_f32 v72, v72
    v_cos_f32 v73, v73
    s_nop 0
    v_fma_f32 v74, v28, v73, -v72
    v_fma_f32 v75, v28, v74, -v73
    v_fma_f32 v76, v28, v75, -v74
    v_fma_f32 v77, v28, v76, -v75
    v_fma_f32 v78, v28, v77, -v76
    v_fma_f32 v79, v28, v78, -v77
    v_cvt_pk_bf16_f32 v64, v72, v73
    v_cvt_pk_bf16_f32 v65, v74, v75
    v_cvt_pk_bf16_f32 v66, v76, v77
    v_cvt_pk_bf16_f32 v67, v78, v79
    ds_read_b128 v[48:51], v15 offset:49152
    ds_read_b128 v[52:55], v15 offset:53248
    ds_read_b128 v[56:59], v15 offset:57344
    ds_read_b128 v[60:63], v15 offset:61440
    s_waitcnt lgkmcnt(4)
    v_mfma_f32_32x32x16_bf16 v[160:175], v[32:35], v[64:67], v[160:175]
    v_mfma_f32_32x32x16_bf16 v[176:191], v[36:39], v[64:67], v[176:191]
    v_mfma_f32_32x32x16_bf16 v[192:207], v[40:43], v[64:67], v[192:207]
    v_mfma_f32_32x32x16_bf16 v[208:223], v[44:47], v[64:67], v[208:223]
    v_fmamk_f32 v72, v23, 0x43500000, v24
    v_fmamk_f32 v73, v23, 0x43510000, v24
    v_cos_f32 v72, v72
    v_cos_f32 v73, v73
    s_nop 0
    v_fma_f32 v74, v28, v73, -v72
    v_fma_f32 v75, v28, v74, -v73
    v_fma_f32 v76, v28, v75, -v74
    v_fma_f32 v77, v28, v76, -v75
    v_fma_f32 v78, v28, v77, -v76
    v_fma_f32 v79, v28, v78, -v77
    v_cvt_pk_bf16_f32 v68, v72, v73
    v_cvt_pk_bf16_f32 v69, v74, v75
    v_cvt_pk_bf16_f32 v70, v76, v77
    v_cvt_pk_bf16_f32 v71, v78, v79
    s_mov_b32 s80, 768
    s_add_u32 m0, s78, 98304
    s_nop 0
    buffer_load_dwordx4 v4, s[8:11], s80 offen lds
    s_add_u32 m0, s78, 99328
    s_nop 0
    buffer_load_dwordx4 v5, s[8:11], s80 offen lds
    ds_read_b128 v[32:35], v16 offset:49152
    ds_read_b128 v[36:39], v16 offset:53248
    ds_read_b128 v[40:43], v16 offset:57344
    ds_read_b128 v[44:47], v16 offset:61440
    s_waitcnt lgkmcnt(4)
    v_mfma_f32_32x32x16_bf16 v[160:175], v[48:51], v[68:71], v[160:175]
    v_mfma_f32_32x32x16_bf16 v[176:191], v[52:55], v[68:71], v[176:191]
    v_mfma_f32_32x32x16_bf16 v[192:207], v[56:59], v[68:71], v[192:207]
    v_mfma_f32_32x32x16_bf16 v[208:223], v[60:63], v[68:71], v[208:223]
    v_fmamk_f32 v72, v23, 0x43600000, v24
    v_fmamk_f32 v73, v23, 0x43610000, v24
    v_cos_f32 v72, v72
    v_cos_f32 v73, v73
    s_nop 0
    v_fma_f32 v74, v28, v73, -v72
    v_fma_f32 v75, v28, v74, -v73
    v_fma_f32 v76, v28, v75, -v74
    v_fma_f32 v77, v28, v76, -v75
    v_fma_f32 v78, v28, v77, -v76
    v_fma_f32 v79, v28, v78, -v77
    v_cvt_pk_bf16_f32 v64, v72, v73
    v_cvt_pk_bf16_f32 v65, v74, v75
    v_cvt_pk_bf16_f32 v66, v76, v77
    v_cvt_pk_bf16_f32 v67, v78, v79
    ds_read_b128 v[48:51], v17 offset:49152
    ds_read_b128 v[52:55], v17 offset:53248
    ds_read_b128 v[56:59], v17 offset:57344
    ds_read_b128 v[60:63], v17 offset:61440
    s_waitcnt lgkmcnt(4)
    v_mfma_f32_32x32x16_bf16 v[160:175], v[32:35], v[64:67], v[160:175]
    v_mfma_f32_32x32x16_bf16 v[176:191], v[36:39], v[64:67], v[176:191]
    v_mfma_f32_32x32x16_bf16 v[192:207], v[40:43], v[64:67], v[192:207]
    v_mfma_f32_32x32x16_bf16 v[208:223], v[44:47], v[64:67], v[208:223]
    v_fmamk_f32 v72, v23, 0x43700000, v24
    v_fmamk_f32 v73, v23, 0x43710000, v24
    v_cos_f32 v72, v72
    v_cos_f32 v73, v73
    s_nop 0
    v_fma_f32 v74, v28, v73, -v72
    v_fma_f32 v75, v28, v74, -v73
    v_fma_f32 v76, v28, v75, -v74
    v_fma_f32 v77, v28, v76, -v75
    v_fma_f32 v78, v28, v77, -v76
    v_fma_f32 v79, v28, v78, -v77
    v_cvt_pk_bf16_f32 v68, v72, v73
    v_cvt_pk_bf16_f32 v69, v74, v75
    v_cvt_pk_bf16_f32 v70, v76, v77
    v_cvt_pk_bf16_f32 v71, v78, v79
    s_waitcnt vmcnt(4)
    s_barrier
    ds_read_b128 v[32:35], v18 offset:0
    ds_read_b128 v[36:39], v18 offset:4096
    ds_read_b128 v[40:43], v18 offset:8192
    ds_read_b128 v[44:47], v18 offset:12288
    s_waitcnt lgkmcnt(4)
    v_mfma_f32_32x32x16_bf16 v[160:175], v[48:51], v[68:71], v[160:175]
    v_mfma_f32_32x32x16_bf16 v[176:191], v[52:55], v[68:71], v[176:191]
    v_mfma_f32_32x32x16_bf16 v[192:207], v[56:59], v[68:71], v[192:207]
    v_mfma_f32_32x32x16_bf16 v[208:223], v[60:63], v[68:71], v[208:223]
    v_fmamk_f32 v72, v23, 0x43800000, v24
    v_fmamk_f32 v73, v23, 0x43808000, v24
    v_cos_f32 v72, v72
    v_cos_f32 v73, v73
    s_nop 0
    v_fma_f32 v74, v28, v73, -v72
    v_fma_f32 v75, v28, v74, -v73
    v_fma_f32 v76, v28, v75, -v74
    v_fma_f32 v77, v28, v76, -v75
    v_fma_f32 v78, v28, v77, -v76
    v_fma_f32 v79, v28, v78, -v77
    v_cvt_pk_bf16_f32 v64, v72, v73
    v_cvt_pk_bf16_f32 v65, v74, v75
    v_cvt_pk_bf16_f32 v66, v76, v77
    v_cvt_pk_bf16_f32 v67, v78, v79
    ds_read_b128 v[48:51], v19 offset:0
    ds_read_b128 v[52:55], v19 offset:4096
    ds_read_b128 v[56:59], v19 offset:8192
    ds_read_b128 v[60:63], v19 offset:12288
    s_waitcnt lgkmcnt(4)
    v_mfma_f32_32x32x16_bf16 v[160:175], v[32:35], v[64:67], v[160:175]
    v_mfma_f32_32x32x16_bf16 v[176:191], v[36:39], v[64:67], v[176:191]
    v_mfma_f32_32x32x16_bf16 v[192:207], v[40:43], v[64:67], v[192:207]
    v_mfma_f32_32x32x16_bf16 v[208:223], v[44:47], v[64:67], v[208:223]
    v_fmamk_f32 v72, v23, 0x43880000, v24
    v_fmamk_f32 v73, v23, 0x43888000, v24
    v_cos_f32 v72, v72
    v_cos_f32 v73, v73
    s_nop 0
    v_fma_f32 v74, v28, v73, -v72
    v_fma_f32 v75, v28, v74, -v73
    v_fma_f32 v76, v28, v75, -v74
    v_fma_f32 v77, v28, v76, -v75
    v_fma_f32 v78, v28, v77, -v76
    v_fma_f32 v79, v28, v78, -v77
    v_cvt_pk_bf16_f32 v68, v72, v73
    v_cvt_pk_bf16_f32 v69, v74, v75
    v_cvt_pk_bf16_f32 v70, v76, v77
    v_cvt_pk_bf16_f32 v71, v78, v79
    ds_read_b128 v[32:35], v20 offset:0
    ds_read_b128 v[36:39], v20 offset:4096
    ds_read_b128 v[40:43], v20 offset:8192
    ds_read_b128 v[44:47], v20 offset:12288
    s_waitcnt lgkmcnt(4)
    v_mfma_f32_32x32x16_bf16 v[160:175], v[48:51], v[68:71], v[160:175]
    v_mfma_f32_32x32x16_bf16 v[176:191], v[52:55], v[68:71], v[176:191]
    v_mfma_f32_32x32x16_bf16 v[192:207], v[56:59], v[68:71], v[192:207]
    v_mfma_f32_32x32x16_bf16 v[208:223], v[60:63], v[68:71], v[208:223]
    v_fmamk_f32 v72, v23, 0x43900000, v24
    v_fmamk_f32 v73, v23, 0x43908000, v24
    v_cos_f32 v72, v72
    v_cos_f32 v73, v73
    s_nop 0
    v_fma_f32 v74, v28, v73, -v72
    v_fma_f32 v75, v28, v74, -v73
    v_fma_f32 v76, v28, v75, -v74
    v_fma_f32 v77, v28, v76, -v75
    v_fma_f32 v78, v28, v77, -v76
    v_fma_f32 v79, v28, v78, -v77
    v_cvt_pk_bf16_f32 v64, v72, v73
    v_cvt_pk_bf16_f32 v65, v74, v75
    v_cvt_pk_bf16_f32 v66, v76, v77
    v_cvt_pk_bf16_f32 v67, v78, v79
    s_lshr_b32 s86, s2, 3
    s_lshl_b32 s86, s86, 3
    s_add_u32 s86, s86, s36
    s_mul_i32 s86, s86, 6272
    v_lshlrev_b32 v146, 7, v1
    buffer_load_dword v147, v146, s[64:67], s86 offen
    ds_read_b128 v[48:51], v21 offset:0
    ds_read_b128 v[52:55], v21 offset:4096
    ds_read_b128 v[56:59], v21 offset:8192
    ds_read_b128 v[60:63], v21 offset:12288
    s_waitcnt lgkmcnt(4)
    v_mfma_f32_32x32x16_bf16 v[160:175], v[32:35], v[64:67], v[160:175]
    v_mfma_f32_32x32x16_bf16 v[176:191], v[36:39], v[64:67], v[176:191]
    v_mfma_f32_32x32x16_bf16 v[192:207], v[40:43], v[64:67], v[192:207]
    v_mfma_f32_32x32x16_bf16 v[208:223], v[44:47], v[64:67], v[208:223]
    v_fmamk_f32 v72, v23, 0x43980000, v24
    v_fmamk_f32 v73, v23, 0x43988000, v24
    v_cos_f32 v72, v72
    v_cos_f32 v73, v73
    s_nop 0
    v_fma_f32 v74, v28, v73, -v72
    v_fma_f32 v75, v28, v74, -v73
    v_fma_f32 v76, v28, v75, -v74
    v_fma_f32 v77, v28, v76, -v75
    v_fma_f32 v78, v28, v77, -v76
    v_fma_f32 v79, v28, v78, -v77
    v_cvt_pk_bf16_f32 v68, v72, v73
    v_cvt_pk_bf16_f32 v69, v74, v75
    v_cvt_pk_bf16_f32 v70, v76, v77
    v_cvt_pk_bf16_f32 v71, v78, v79
    s_waitcnt vmcnt(3)
    s_barrier
    ds_read_b128 v[32:35], v18 offset:16384
    ds_read_b128 v[36:39], v18 offset:20480
    ds_read_b128 v[40:43], v18 offset:24576
    ds_read_b128 v[44:47], v18 offset:28672
    s_waitcnt lgkmcnt(4)
    v_mfma_f32_32x32x16_bf16 v[160:175], v[48:51], v[68:71], v[160:175]
    v_mfma_f32_32x32x16_bf16 v[176:191], v[52:55], v[68:71], v[176:191]
    v_mfma_f32_32x32x16_bf16 v[192:207], v[56:59], v[68:71], v[192:207]
    v_mfma_f32_32x32x16_bf16 v[208:223], v[60:63], v[68:71], v[208:223]
    v_fmamk_f32 v72, v23, 0x43a00000, v24
    v_fmamk_f32 v73, v23, 0x43a08000, v24
    v_cos_f32 v72, v72
    v_cos_f32 v73, v73
    s_nop 0
    v_fma_f32 v74, v28, v73, -v72
    v_fma_f32 v75, v28, v74, -v73
    v_fma_f32 v76, v28, v75, -v74
    v_fma_f32 v77, v28, v76, -v75
    v_fma_f32 v78, v28, v77, -v76
    v_fma_f32 v79, v28, v78, -v77
    v_cvt_pk_bf16_f32 v64, v72, v73
    v_cvt_pk_bf16_f32 v65, v74, v75
    v_cvt_pk_bf16_f32 v66, v76, v77
    v_cvt_pk_bf16_f32 v67, v78, v79
    ds_read_b128 v[48:51], v19 offset:16384
    ds_read_b128 v[52:55], v19 offset:20480
    ds_read_b128 v[56:59], v19 offset:24576
    ds_read_b128 v[60:63], v19 offset:28672
    s_waitcnt lgkmcnt(4)
    v_mfma_f32_32x32x16_bf16 v[160:175], v[32:35], v[64:67], v[160:175]
    v_mfma_f32_32x32x16_bf16 v[176:191], v[36:39], v[64:67], v[176:191]
    v_mfma_f32_32x32x16_bf16 v[192:207], v[40:43], v[64:67], v[192:207]
    v_mfma_f32_32x32x16_bf16 v[208:223], v[44:47], v[64:67], v[208:223]
    v_fmamk_f32 v72, v23, 0x43a80000, v24
    v_fmamk_f32 v73, v23, 0x43a88000, v24
    v_cos_f32 v72, v72
    v_cos_f32 v73, v73
    s_nop 0
    v_fma_f32 v74, v28, v73, -v72
    v_fma_f32 v75, v28, v74, -v73
    v_fma_f32 v76, v28, v75, -v74
    v_fma_f32 v77, v28, v76, -v75
    v_fma_f32 v78, v28, v77, -v76
    v_fma_f32 v79, v28, v78, -v77
    v_cvt_pk_bf16_f32 v68, v72, v73
    v_cvt_pk_bf16_f32 v69, v74, v75
    v_cvt_pk_bf16_f32 v70, v76, v77
    v_cvt_pk_bf16_f32 v71, v78, v79
    ds_read_b128 v[32:35], v20 offset:16384
    ds_read_b128 v[36:39], v20 offset:20480
    ds_read_b128 v[40:43], v20 offset:24576
    ds_read_b128 v[44:47], v20 offset:28672
    s_waitcnt lgkmcnt(4)
    v_mfma_f32_32x32x16_bf16 v[160:175], v[48:51], v[68:71], v[160:175]
    v_mfma_f32_32x32x16_bf16 v[176:191], v[52:55], v[68:71], v[176:191]
    v_mfma_f32_32x32x16_bf16 v[192:207], v[56:59], v[68:71], v[192:207]
    v_mfma_f32_32x32x16_bf16 v[208:223], v[60:63], v[68:71], v[208:223]
    v_fmamk_f32 v72, v23, 0x43b00000, v24
    v_fmamk_f32 v73, v23, 0x43b08000, v24
    v_cos_f32 v72, v72
    v_cos_f32 v73, v73
    s_nop 0
    v_fma_f32 v74, v28, v73, -v72
    v_fma_f32 v75, v28, v74, -v73
    v_fma_f32 v76, v28, v75, -v74
    v_fma_f32 v77, v28, v76, -v75
    v_fma_f32 v78, v28, v77, -v76
    v_fma_f32 v79, v28, v78, -v77
    v_cvt_pk_bf16_f32 v64, v72, v73
    v_cvt_pk_bf16_f32 v65, v74, v75
    v_cvt_pk_bf16_f32 v66, v76, v77
    v_cvt_pk_bf16_f32 v67, v78, v79
    ds_read_b128 v[48:51], v21 offset:16384
    ds_read_b128 v[52:55], v21 offset:20480
    ds_read_b128 v[56:59], v21 offset:24576
    ds_read_b128 v[60:63], v21 offset:28672
    s_waitcnt lgkmcnt(4)
    v_mfma_f32_32x32x16_bf16 v[160:175], v[32:35], v[64:67], v[160:175]
    v_mfma_f32_32x32x16_bf16 v[176:191], v[36:39], v[64:67], v[176:191]
    v_mfma_f32_32x32x16_bf16 v[192:207], v[40:43], v[64:67], v[192:207]
    v_mfma_f32_32x32x16_bf16 v[208:223], v[44:47], v[64:67], v[208:223]
    v_fmamk_f32 v72, v23, 0x43b80000, v24
    v_fmamk_f32 v73, v23, 0x43b88000, v24
    v_cos_f32 v72, v72
    v_cos_f32 v73, v73
    s_nop 0
    v_fma_f32 v74, v28, v73, -v72
    v_fma_f32 v75, v28, v74, -v73
    v_fma_f32 v76, v28, v75, -v74
    v_fma_f32 v77, v28, v76, -v75
    v_fma_f32 v78, v28, v77, -v76
    v_fma_f32 v79, v28, v78, -v77
    v_cvt_pk_bf16_f32 v68, v72, v73
    v_cvt_pk_bf16_f32 v69, v74, v75
    v_cvt_pk_bf16_f32 v70, v76, v77
    v_cvt_pk_bf16_f32 v71, v78, v79
    s_waitcnt vmcnt(1)
    s_barrier
    ds_read_b128 v[32:35], v18 offset:32768
    ds_read_b128 v[36:39], v18 offset:36864
    ds_read_b128 v[40:43], v18 offset:40960
    ds_read_b128 v[44:47], v18 offset:45056
    s_waitcnt lgkmcnt(4)
    v_mfma_f32_32x32x16_bf16 v[160:175], v[48:51], v[68:71], v[160:175]
    v_mfma_f32_32x32x16_bf16 v[176:191], v[52:55], v[68:71], v[176:191]
    v_mfma_f32_32x32x16_bf16 v[192:207], v[56:59], v[68:71], v[192:207]
    v_mfma_f32_32x32x16_bf16 v[208:223], v[60:63], v[68:71], v[208:223]
    v_fmamk_f32 v72, v23, 0x43c00000, v24
    v_fmamk_f32 v73, v23, 0x43c08000, v24
    v_cos_f32 v72, v72
    v_cos_f32 v73, v73
    s_nop 0
    v_fma_f32 v74, v28, v73, -v72
    v_fma_f32 v75, v28, v74, -v73
    v_fma_f32 v76, v28, v75, -v74
    v_fma_f32 v77, v28, v76, -v75
    v_fma_f32 v78, v28, v77, -v76
    v_fma_f32 v79, v28, v78, -v77
    v_cvt_pk_bf16_f32 v64, v72, v73
    v_cvt_pk_bf16_f32 v65, v74, v75
    v_cvt_pk_bf16_f32 v66, v76, v77
    v_cvt_pk_bf16_f32 v67, v78, v79
    ds_read_b128 v[48:51], v19 offset:32768
    ds_read_b128 v[52:55], v19 offset:36864
    ds_read_b128 v[56:59], v19 offset:40960
    ds_read_b128 v[60:63], v19 offset:45056
    s_waitcnt lgkmcnt(4)
    v_mfma_f32_32x32x16_bf16 v[160:175], v[32:35], v[64:67], v[160:175]
    v_mfma_f32_32x32x16_bf16 v[176:191], v[36:39], v[64:67], v[176:191]
    v_mfma_f32_32x32x16_bf16 v[192:207], v[40:43], v[64:67], v[192:207]
    v_mfma_f32_32x32x16_bf16 v[208:223], v[44:47], v[64:67], v[208:223]
    v_fmamk_f32 v72, v23, 0x43c80000, v24
    v_fmamk_f32 v73, v23, 0x43c88000, v24
    v_cos_f32 v72, v72
    v_cos_f32 v73, v73
    s_nop 0
    v_fma_f32 v74, v28, v73, -v72
    v_fma_f32 v75, v28, v74, -v73
    v_fma_f32 v76, v28, v75, -v74
    v_fma_f32 v77, v28, v76, -v75
    v_fma_f32 v78, v28, v77, -v76
    v_fma_f32 v79, v28, v78, -v77
    v_cvt_pk_bf16_f32 v68, v72, v73
    v_cvt_pk_bf16_f32 v69, v74, v75
    v_cvt_pk_bf16_f32 v70, v76, v77
    v_cvt_pk_bf16_f32 v71, v78, v79
    ds_read_b128 v[32:35], v20 offset:32768
    ds_read_b128 v[36:39], v20 offset:36864
    ds_read_b128 v[40:43], v20 offset:40960
    ds_read_b128 v[44:47], v20 offset:45056
    s_waitcnt lgkmcnt(4)
    v_mfma_f32_32x32x16_bf16 v[160:175], v[48:51], v[68:71], v[160:175]
    v_mfma_f32_32x32x16_bf16 v[176:191], v[52:55], v[68:71], v[176:191]
    v_mfma_f32_32x32x16_bf16 v[192:207], v[56:59], v[68:71], v[192:207]
    v_mfma_f32_32x32x16_bf16 v[208:223], v[60:63], v[68:71], v[208:223]
    v_fmamk_f32 v72, v23, 0x43d00000, v24
    v_fmamk_f32 v73, v23, 0x43d08000, v24
    v_cos_f32 v72, v72
    v_cos_f32 v73, v73
    s_nop 0
    v_fma_f32 v74, v28, v73, -v72
    v_fma_f32 v75, v28, v74, -v73
    v_fma_f32 v76, v28, v75, -v74
    v_fma_f32 v77, v28, v76, -v75
    v_fma_f32 v78, v28, v77, -v76
    v_fma_f32 v79, v28, v78, -v77
    v_cvt_pk_bf16_f32 v64, v72, v73
    v_cvt_pk_bf16_f32 v65, v74, v75
    v_cvt_pk_bf16_f32 v66, v76, v77
    v_cvt_pk_bf16_f32 v67, v78, v79
    ds_read_b128 v[48:51], v21 offset:32768
    ds_read_b128 v[52:55], v21 offset:36864
    ds_read_b128 v[56:59], v21 offset:40960
    ds_read_b128 v[60:63], v21 offset:45056
    s_waitcnt lgkmcnt(4)
    v_mfma_f32_32x32x16_bf16 v[160:175], v[32:35], v[64:67], v[160:175]
    v_mfma_f32_32x32x16_bf16 v[176:191], v[36:39], v[64:67], v[176:191]
    v_mfma_f32_32x32x16_bf16 v[192:207], v[40:43], v[64:67], v[192:207]
    v_mfma_f32_32x32x16_bf16 v[208:223], v[44:47], v[64:67], v[208:223]
    v_fmamk_f32 v72, v23, 0x43d80000, v24
    v_fmamk_f32 v73, v23, 0x43d88000, v24
    v_cos_f32 v72, v72
    v_cos_f32 v73, v73
    s_nop 0
    v_fma_f32 v74, v28, v73, -v72
    v_fma_f32 v75, v28, v74, -v73
    v_fma_f32 v76, v28, v75, -v74
    v_fma_f32 v77, v28, v76, -v75
    v_fma_f32 v78, v28, v77, -v76
    v_fma_f32 v79, v28, v78, -v77
    v_cvt_pk_bf16_f32 v68, v72, v73
    v_cvt_pk_bf16_f32 v69, v74, v75
    v_cvt_pk_bf16_f32 v70, v76, v77
    v_cvt_pk_bf16_f32 v71, v78, v79
    s_waitcnt lgkmcnt(0)
    s_nop 0
    v_mfma_f32_32x32x16_bf16 v[160:175], v[48:51], v[68:71], v[160:175]
    v_mfma_f32_32x32x16_bf16 v[176:191], v[52:55], v[68:71], v[176:191]
    v_mfma_f32_32x32x16_bf16 v[192:207], v[56:59], v[68:71], v[192:207]
    v_mfma_f32_32x32x16_bf16 v[208:223], v[60:63], v[68:71], v[208:223]
    s_nop 8
    v_cvt_pk_bf16_f32 v32, v160, v161
    v_cvt_pk_bf16_f32 v33, v162, v163
    v_cvt_pk_bf16_f32 v34, v164, v165
    v_cvt_pk_bf16_f32 v35, v166, v167
    v_cvt_pk_bf16_f32 v36, v168, v169
    v_cvt_pk_bf16_f32 v37, v170, v171
    v_cvt_pk_bf16_f32 v38, v172, v173
    v_cvt_pk_bf16_f32 v39, v174, v175
    ds_write_b128 v25, v[32:35] offset:0
    ds_write_b128 v25, v[36:39] offset:32
    v_cvt_pk_bf16_f32 v40, v176, v177
    v_cvt_pk_bf16_f32 v41, v178, v179
    v_cvt_pk_bf16_f32 v42, v180, v181
    v_cvt_pk_bf16_f32 v43, v182, v183
    v_cvt_pk_bf16_f32 v44, v184, v185
    v_cvt_pk_bf16_f32 v45, v186, v187
    v_cvt_pk_bf16_f32 v46, v188, v189
    v_cvt_pk_bf16_f32 v47, v190, v191
    ds_write_b128 v25, v[40:43] offset:64
    ds_write_b128 v25, v[44:47] offset:96
    v_cvt_pk_bf16_f32 v48, v192, v193
    v_cvt_pk_bf16_f32 v49, v194, v195
    v_cvt_pk_bf16_f32 v50, v196, v197
    v_cvt_pk_bf16_f32 v51, v198, v199
    v_cvt_pk_bf16_f32 v52, v200, v201
    v_cvt_pk_bf16_f32 v53, v202, v203
    v_cvt_pk_bf16_f32 v54, v204, v205
    v_cvt_pk_bf16_f32 v55, v206, v207
    ds_write_b128 v25, v[48:51] offset:128
    ds_write_b128 v25, v[52:55] offset:160
    v_cvt_pk_bf16_f32 v56, v208, v209
    v_cvt_pk_bf16_f32 v57, v210, v211
    v_cvt_pk_bf16_f32 v58, v212, v213
    v_cvt_pk_bf16_f32 v59, v214, v215
    v_cvt_pk_bf16_f32 v60, v216, v217
    v_cvt_pk_bf16_f32 v61, v218, v219
    v_cvt_pk_bf16_f32 v62, v220, v221
    v_cvt_pk_bf16_f32 v63, v222, v223
    ds_write_b128 v25, v[56:59] offset:192
    ds_write_b128 v25, v[60:63] offset:224
    s_waitcnt lgkmcnt(0)
    ds_read_b128 v[64:67], v26 offset:0
    ds_read_b128 v[68:71], v26 offset:1088
    ds_read_b128 v[72:75], v26 offset:2176
    ds_read_b128 v[76:79], v26 offset:3264
    ds_read_b128 v[80:83], v26 offset:4352
    ds_read_b128 v[84:87], v26 offset:5440
    ds_read_b128 v[88:91], v26 offset:6528
    ds_read_b128 v[92:95], v26 offset:7616
    s_waitcnt lgkmcnt(7)
    s_add_u32 s85, s84, 0
    buffer_store_dwordx4 v[64:67], v27, s[20:23], s85 offen sc0 sc1
    s_waitcnt lgkmcnt(6)
    s_add_u32 s85, s84, 16384
    buffer_store_dwordx4 v[68:71], v27, s[20:23], s85 offen sc0 sc1
    s_waitcnt lgkmcnt(5)
    s_add_u32 s85, s84, 32768
    buffer_store_dwordx4 v[72:75], v27, s[20:23], s85 offen sc0 sc1
    s_waitcnt lgkmcnt(4)
    s_add_u32 s85, s84, 49152
    buffer_store_dwordx4 v[76:79], v27, s[20:23], s85 offen sc0 sc1
    s_waitcnt lgkmcnt(3)
    s_add_u32 s85, s84, 65536
    buffer_store_dwordx4 v[80:83], v27, s[20:23], s85 offen sc0 sc1
    s_waitcnt lgkmcnt(2)
    s_add_u32 s85, s84, 81920
    buffer_store_dwordx4 v[84:87], v27, s[20:23], s85 offen sc0 sc1
    s_waitcnt lgkmcnt(1)
    s_add_u32 s85, s84, 98304
    buffer_store_dwordx4 v[88:91], v27, s[20:23], s85 offen sc0 sc1
    s_waitcnt lgkmcnt(0)
    s_add_u32 s85, s84, 114688
    buffer_store_dwordx4 v[92:95], v27, s[20:23], s85 offen sc0 sc1
    s_endpgm
K1_END:
    s_endpgm
.globl k2_down_fft_kernel
.p2align 8
.type k2_down_fft_kernel,@function
k2_down_fft_kernel:
    s_cmp_ge_u32 s2, 225
    s_cbranch_scc1 K2_END
    s_load_dwordx2 s[4:5], s[0:1], 48
    s_load_dwordx2 s[60:61], s[0:1], 64
    s_load_dwordx2 s[6:7], s[0:1], 80
    v_and_b32 v1, 63, v0
    v_lshrrev_b32 v2, 6, v0
    s_nop 0
    v_readfirstlane_b32 s36, v2
    s_waitcnt lgkmcnt(0)
    s_mov_b32 s8, s4
    s_mov_b32 s9, s5
    s_mov_b32 s10, 1605632
    s_mov_b32 s11, 0x00020000
    s_mov_b32 s20, s6
    s_mov_b32 s21, s7
    s_mov_b32 s22, 17825792
    s_mov_b32 s23, 0x00020000
    s_mov_b32 s12, s60
    s_mov_b32 s13, s61
    s_mov_b32 s14, 1835008
    s_mov_b32 s15, 0x00020000
    s_and_b32 s72, s2, 7
    s_lshl_b32 s72, s72, 2
    s_lshr_b32 s73, s2, 3
    s_and_b32 s74, s73, 3
    s_add_u32 s74, s74, s72
    s_lshr_b32 s75, s2, 5
    s_lshl_b32 s78, s36, 14
    s_cmp_eq_u32 s36, 7
    s_cbranch_scc1 K2_FFT
    s_cmp_ge_u32 s2, 224
    s_cbranch_scc1 K2_END
    v_lshrrev_b32 v8, 3, v1
    v_mul_u32_u24 v9, 896, v8
    v_lshrrev_b32 v10, 4, v1
    v_and_b32 v10, 1, v10
    v_lshlrev_b32 v10, 2, v10
    v_and_b32 v11, 7, v1
    v_xor_b32 v10, v11, v10
    v_lshl_add_u32 v3, v10, 4, v9
    s_lshl_b32 s76, s75, 7
    s_mul_i32 s77, s36, 229376
    s_add_u32 s76, s76, s77
    v_add_u32 v3, s76, v3
    s_mul_i32 s76, s74, 224
    s_lshl_b32 s77, s36, 4
    s_add_u32 s76, s76, s77
    s_lshl_b32 s76, s76, 10
    v_lshlrev_b32 v4, 4, v1
    v_add_u32 v4, s76, v4
    s_barrier
    v_and_b32 v14, 31, v1
    v_lshlrev_b32 v14, 2, v14
    s_lshl_b32 s86, s74, 8
    s_add_u32 s86, s86, 0xb00000
    buffer_load_dword v80, v14, s[20:23], s86 offen
    buffer_load_dword v81, v14, s[20:23], s86 offen offset:128
    s_mov_b32 s80, 0
    s_mov_b32 s81, 7168
    s_mov_b32 s82, 0
    s_mov_b32 s83, 114688
    s_add_u32 m0, s78, 0
    s_nop 0
    buffer_load_dwordx4 v3, s[8:11], s80 offen lds
    s_add_u32 m0, s78, 1024
    s_nop 0
    buffer_load_dwordx4 v3, s[8:11], s81 offen lds
    buffer_load_dwordx4 v[16:19], v4, s[20:23], s82 offen
    buffer_load_dwordx4 v[20:23], v4, s[20:23], s83 offen
    s_mov_b32 s80, 14336
    s_mov_b32 s81, 21504
    s_mov_b32 s82, 1024
    s_mov_b32 s83, 115712
    s_add_u32 m0, s78, 2048
    s_nop 0
    buffer_load_dwordx4 v3, s[8:11], s80 offen lds
    s_add_u32 m0, s78, 3072
    s_nop 0
    buffer_load_dwordx4 v3, s[8:11], s81 offen lds
    buffer_load_dwordx4 v[24:27], v4, s[20:23], s82 offen
    buffer_load_dwordx4 v[28:31], v4, s[20:23], s83 offen
    s_mov_b32 s80, 28672
    s_mov_b32 s81, 35840
    s_mov_b32 s82, 2048
    s_mov_b32 s83, 116736
    s_add_u32 m0, s78, 4096
    s_nop 0
    buffer_load_dwordx4 v3, s[8:11], s80 offen lds
    s_add_u32 m0, s78, 5120
    s_nop 0
    buffer_load_dwordx4 v3, s[8:11], s81 offen lds
    buffer_load_dwordx4 v[32:35], v4, s[20:23], s82 offen
    buffer_load_dwordx4 v[36:39], v4, s[20:23], s83 offen
    s_mov_b32 s80, 43008
    s_mov_b32 s81, 50176
    s_mov_b32 s82, 3072
    s_mov_b32 s83, 117760
    s_add_u32 m0, s78, 6144
    s_nop 0
    buffer_load_dwordx4 v3, s[8:11], s80 offen lds
    s_add_u32 m0, s78, 7168
    s_nop 0
    buffer_load_dwordx4 v3, s[8:11], s81 offen lds
    buffer_load_dwordx4 v[40:43], v4, s[20:23], s82 offen
    buffer_load_dwordx4 v[44:47], v4, s[20:23], s83 offen
    s_mov_b32 s80, 57344
    s_mov_b32 s81, 64512
    s_mov_b32 s82, 4096
    s_mov_b32 s83, 118784
    s_add_u32 m0, s78, 8192
    s_nop 0
    buffer_load_dwordx4 v3, s[8:11], s80 offen lds
    s_add_u32 m0, s78, 9216
    s_nop 0
    buffer_load_dwordx4 v3, s[8:11], s81 offen lds
    buffer_load_dwordx4 v[48:51], v4, s[20:23], s82 offen
    buffer_load_dwordx4 v[52:55], v4, s[20:23], s83 offen
    s_mov_b32 s80, 71680
    s_mov_b32 s81, 78848
    s_mov_b32 s82, 5120
    s_mov_b32 s83, 119808
    s_add_u32 m0, s78, 10240
    s_nop 0
    buffer_load_dwordx4 v3, s[8:11], s80 offen lds
    s_add_u32 m0, s78, 11264
    s_nop 0
    buffer_load_dwordx4 v3, s[8:11], s81 offen lds
    buffer_load_dwordx4 v[56:59], v4, s[20:23], s82 offen
    buffer_load_dwordx4 v[60:63], v4, s[20:23], s83 offen
    v_and_b32 v8, 15, v1
    v_lshrrev_b32 v9, 2, v8
    v_lshrrev_b32 v10, 5, v1
    v_lshl_add_u32 v9, v10, 2, v9
    v_lshlrev_b32 v9, 7, v9
    v_lshrrev_b32 v10, 4, v1
    v_and_b32 v10, 1, v10
    v_lshlrev_b32 v10, 1, v10
    v_lshrrev_b32 v11, 1, v8
    v_and_b32 v11, 1, v11
    v_add_u32 v10, v10, v11
    v_add_u32 v10, 0, v10
    v_lshrrev_b32 v11, 3, v8
    v_lshlrev_b32 v11, 2, v11
    v_xor_b32 v10, v10, v11
    v_lshl_add_u32 v9, v10, 4, v9
    v_and_b32 v11, 1, v8
    v_lshl_add_u32 v5, v11, 3, v9
    v_add_u32 v5, s78, v5
    v_xor_b32 v6, 64, v5
    s_waitcnt vmcnt(20)
    v_sub_f32 v92, 1.0, v80
    v_sub_f32 v93, 1.0, v81
    v_mul_f32 v80, 0x36124925, v80
    v_mul_f32 v81, 0x36124925, v81
    ds_read_b64_tr_b16 v[128:129], v5 offset:0
    ds_read_b64_tr_b16 v[130:131], v5 offset:1024
    ds_read_b64_tr_b16 v[132:133], v6 offset:0
    ds_read_b64_tr_b16 v[134:135], v6 offset:1024
    s_waitcnt vmcnt(16)
    ds_read_b64_tr_b16 v[136:137], v5 offset:2048
    ds_read_b64_tr_b16 v[138:139], v5 offset:3072
    ds_read_b64_tr_b16 v[140:141], v6 offset:2048
    ds_read_b64_tr_b16 v[142:143], v6 offset:3072
    s_waitcnt lgkmcnt(4)
    v_mfma_f32_32x32x16_bf16 v[144:159], v[128:131], v[16:19], 0
    v_mfma_f32_32x32x16_bf16 v[160:175], v[128:131], v[20:23], 0
    v_mfma_f32_32x32x16_bf16 v[176:191], v[132:135], v[16:19], 0
    v_mfma_f32_32x32x16_bf16 v[192:207], v[132:135], v[20:23], 0
    s_mov_b32 s80, 86016
    s_mov_b32 s81, 93184
    s_mov_b32 s82, 6144
    s_mov_b32 s83, 120832
    s_add_u32 m0, s78, 12288
    s_nop 0
    buffer_load_dwordx4 v3, s[8:11], s80 offen lds
    s_add_u32 m0, s78, 13312
    s_nop 0
    buffer_load_dwordx4 v3, s[8:11], s81 offen lds
    buffer_load_dwordx4 v[64:67], v4, s[20:23], s82 offen
    buffer_load_dwordx4 v[68:71], v4, s[20:23], s83 offen
    s_waitcnt vmcnt(16)
    ds_read_b64_tr_b16 v[128:129], v5 offset:4096
    ds_read_b64_tr_b16 v[130:131], v5 offset:5120
    ds_read_b64_tr_b16 v[132:133], v6 offset:4096
    ds_read_b64_tr_b16 v[134:135], v6 offset:5120
    s_waitcnt lgkmcnt(4)
    v_mfma_f32_32x32x16_bf16 v[144:159], v[136:139], v[24:27], v[144:159]
    v_mfma_f32_32x32x16_bf16 v[160:175], v[136:139], v[28:31], v[160:175]
    v_mfma_f32_32x32x16_bf16 v[176:191], v[140:143], v[24:27], v[176:191]
    v_mfma_f32_32x32x16_bf16 v[192:207], v[140:143], v[28:31], v[192:207]
    s_mov_b32 s80, 100352
    s_mov_b32 s81, 107520
    s_mov_b32 s82, 7168
    s_mov_b32 s83, 121856
    s_add_u32 m0, s78, 14336
    s_nop 0
    buffer_load_dwordx4 v3, s[8:11], s80 offen lds
    s_add_u32 m0, s78, 15360
    s_nop 0
    buffer_load_dwordx4 v3, s[8:11], s81 offen lds
    buffer_load_dwordx4 v[72:75], v4, s[20:23], s82 offen
    buffer_load_dwordx4 v[76:79], v4, s[20:23], s83 offen
    s_waitcnt vmcnt(16)
    ds_read_b64_tr_b16 v[136:137], v5 offset:6144
    ds_read_b64_tr_b16 v[138:139], v5 offset:7168
    ds_read_b64_tr_b16 v[140:141], v6 offset:6144
    ds_read_b64_tr_b16 v[142:143], v6 offset:7168
    s_waitcnt lgkmcnt(4)
    v_mfma_f32_32x32x16_bf16 v[144:159], v[128:131], v[32:35], v[144:159]
    v_mfma_f32_32x32x16_bf16 v[160:175], v[128:131], v[36:39], v[160:175]
    v_mfma_f32_32x32x16_bf16 v[176:191], v[132:135], v[32:35], v[176:191]
    v_mfma_f32_32x32x16_bf16 v[192:207], v[132:135], v[36:39], v[192:207]
    s_mov_b32 s80, 114688
    s_mov_b32 s81, 121856
    s_mov_b32 s82, 8192
    s_mov_b32 s83, 122880
    s_add_u32 m0, s78, 0
    s_nop 0
    buffer_load_dwordx4 v3, s[8:11], s80 offen lds
    s_add_u32 m0, s78, 1024
    s_nop 0
    buffer_load_dwordx4 v3, s[8:11], s81 offen lds
    buffer_load_dwordx4 v[16:19], v4, s[20:23], s82 offen
    buffer_load_dwordx4 v[20:23], v4, s[20:23], s83 offen
    s_waitcnt vmcnt(16)
    ds_read_b64_tr_b16 v[128:129], v5 offset:8192
    ds_read_b64_tr_b16 v[130:131], v5 offset:9216
    ds_read_b64_tr_b16 v[132:133], v6 offset:8192
    ds_read_b64_tr_b16 v[134:135], v6 offset:9216
    s_waitcnt lgkmcnt(4)
    v_mfma_f32_32x32x16_bf16 v[144:159], v[136:139], v[40:43], v[144:159]
    v_mfma_f32_32x32x16_bf16 v[160:175], v[136:139], v[44:47], v[160:175]
    v_mfma_f32_32x32x16_bf16 v[176:191], v[140:143], v[40:43], v[176:191]
    v_mfma_f32_32x32x16_bf16 v[192:207], v[140:143], v[44:47], v[192:207]
    s_mov_b32 s80, 129024
    s_mov_b32 s81, 136192
    s_mov_b32 s82, 9216
    s_mov_b32 s83, 123904
    s_add_u32 m0, s78, 2048
    s_nop 0
    buffer_load_dwordx4 v3, s[8:11], s80 offen lds
    s_add_u32 m0, s78, 3072
    s_nop 0
    buffer_load_dwordx4 v3, s[8:11], s81 offen lds
    buffer_load_dwordx4 v[24:27], v4, s[20:23], s82 offen
    buffer_load_dwordx4 v[28:31], v4, s[20:23], s83 offen
    s_waitcnt vmcnt(16)
    ds_read_b64_tr_b16 v[136:137], v5 offset:10240
    ds_read_b64_tr_b16 v[138:139], v5 offset:11264
    ds_read_b64_tr_b16 v[140:141], v6 offset:10240
    ds_read_b64_tr_b16 v[142:143], v6 offset:11264
    s_waitcnt lgkmcnt(4)
    v_mfma_f32_32x32x16_bf16 v[144:159], v[128:131], v[48:51], v[144:159]
    v_mfma_f32_32x32x16_bf16 v[160:175], v[128:131], v[52:55], v[160:175]
    v_mfma_f32_32x32x16_bf16 v[176:191], v[132:135], v[48:51], v[176:191]
    v_mfma_f32_32x32x16_bf16 v[192:207], v[132:135], v[52:55], v[192:207]
    s_mov_b32 s80, 143360
    s_mov_b32 s81, 150528
    s_mov_b32 s82, 10240
    s_mov_b32 s83, 124928
    s_add_u32 m0, s78, 4096
    s_nop 0
    buffer_load_dwordx4 v3, s[8:11], s80 offen lds
    s_add_u32 m0, s78, 5120
    s_nop 0
    buffer_load_dwordx4 v3, s[8:11], s81 offen lds
    buffer_load_dwordx4 v[32:35], v4, s[20:23], s82 offen
    buffer_load_dwordx4 v[36:39], v4, s[20:23], s83 offen
    s_waitcnt vmcnt(16)
    ds_read_b64_tr_b16 v[128:129], v5 offset:12288
    ds_read_b64_tr_b16 v[130:131], v5 offset:13312
    ds_read_b64_tr_b16 v[132:133], v6 offset:12288
    ds_read_b64_tr_b16 v[134:135], v6 offset:13312
    s_waitcnt lgkmcnt(4)
    v_mfma_f32_32x32x16_bf16 v[144:159], v[136:139], v[56:59], v[144:159]
    v_mfma_f32_32x32x16_bf16 v[160:175], v[136:139], v[60:63], v[160:175]
    v_mfma_f32_32x32x16_bf16 v[176:191], v[140:143], v[56:59], v[176:191]
    v_mfma_f32_32x32x16_bf16 v[192:207], v[140:143], v[60:63], v[192:207]
    s_mov_b32 s80, 157696
    s_mov_b32 s81, 164864
    s_mov_b32 s82, 11264
    s_mov_b32 s83, 125952
    s_add_u32 m0, s78, 6144
    s_nop 0
    buffer_load_dwordx4 v3, s[8:11], s80 offen lds
    s_add_u32 m0, s78, 7168
    s_nop 0
    buffer_load_dwordx4 v3, s[8:11], s81 offen lds
    buffer_load_dwordx4 v[40:43], v4, s[20:23], s82 offen
    buffer_load_dwordx4 v[44:47], v4, s[20:23], s83 offen
    s_waitcnt vmcnt(16)
    ds_read_b64_tr_b16 v[136:137], v5 offset:14336
    ds_read_b64_tr_b16 v[138:139], v5 offset:15360
    ds_read_b64_tr_b16 v[140:141], v6 offset:14336
    ds_read_b64_tr_b16 v[142:143], v6 offset:15360
    s_waitcnt lgkmcnt(4)
    v_mfma_f32_32x32x16_bf16 v[144:159], v[128:131], v[64:67], v[144:159]
    v_mfma_f32_32x32x16_bf16 v[160:175], v[128:131], v[68:71], v[160:175]
    v_mfma_f32_32x32x16_bf16 v[176:191], v[132:135], v[64:67], v[176:191]
    v_mfma_f32_32x32x16_bf16 v[192:207], v[132:135], v[68:71], v[192:207]
    s_mov_b32 s80, 172032
    s_mov_b32 s81, 179200
    s_mov_b32 s82, 12288
    s_mov_b32 s83, 126976
    s_add_u32 m0, s78, 8192
    s_nop 0
    buffer_load_dwordx4 v3, s[8:11], s80 offen lds
    s_add_u32 m0, s78, 9216
    s_nop 0
    buffer_load_dwordx4 v3, s[8:11], s81 offen lds
    buffer_load_dwordx4 v[48:51], v4, s[20:23], s82 offen
    buffer_load_dwordx4 v[52:55], v4, s[20:23], s83 offen
    s_waitcnt vmcnt(16)
    ds_read_b64_tr_b16 v[128:129], v5 offset:0
    ds_read_b64_tr_b16 v[130:131], v5 offset:1024
    ds_read_b64_tr_b16 v[132:133], v6 offset:0
    ds_read_b64_tr_b16 v[134:135], v6 offset:1024
    s_waitcnt lgkmcnt(4)
    v_mfma_f32_32x32x16_bf16 v[144:159], v[136:139], v[72:75], v[144:159]
    v_mfma_f32_32x32x16_bf16 v[160:175], v[136:139], v[76:79], v[160:175]
    v_mfma_f32_32x32x16_bf16 v[176:191], v[140:143], v[72:75], v[176:191]
    v_mfma_f32_32x32x16_bf16 v[192:207], v[140:143], v[76:79], v[192:207]
    s_mov_b32 s80, 186368
    s_mov_b32 s81, 193536
    s_mov_b32 s82, 13312
    s_mov_b32 s83, 128000
    s_add_u32 m0, s78, 10240
    s_nop 0
    buffer_load_dwordx4 v3, s[8:11], s80 offen lds
    s_add_u32 m0, s78, 11264
    s_nop 0
    buffer_load_dwordx4 v3, s[8:11], s81 offen lds
    buffer_load_dwordx4 v[56:59], v4, s[20:23], s82 offen
    buffer_load_dwordx4 v[60:63], v4, s[20:23], s83 offen
    s_waitcnt vmcnt(16)
    ds_read_b64_tr_b16 v[136:137], v5 offset:2048
    ds_read_b64_tr_b16 v[138:139], v5 offset:3072
    ds_read_b64_tr_b16 v[140:141], v6 offset:2048
    ds_read_b64_tr_b16 v[142:143], v6 offset:3072
    s_waitcnt lgkmcnt(4)
    v_mfma_f32_32x32x16_bf16 v[144:159], v[128:131], v[16:19], v[144:159]
    v_mfma_f32_32x32x16_bf16 v[160:175], v[128:131], v[20:23], v[160:175]
    v_mfma_f32_32x32x16_bf16 v[176:191], v[132:135], v[16:19], v[176:191]
    v_mfma_f32_32x32x16_bf16 v[192:207], v[132:135], v[20:23], v[192:207]
    s_mov_b32 s80, 200704
    s_mov_b32 s81, 207872
    s_mov_b32 s82, 14336
    s_mov_b32 s83, 129024
    s_add_u32 m0, s78, 12288
    s_nop 0
    buffer_load_dwordx4 v3, s[8:11], s80 offen lds
    s_add_u32 m0, s78, 13312
    s_nop 0
    buffer_load_dwordx4 v3, s[8:11], s81 offen lds
    buffer_load_dwordx4 v[64:67], v4, s[20:23], s82 offen
    buffer_load_dwordx4 v[68:71], v4, s[20:23], s83 offen
    s_waitcnt vmcnt(16)
    ds_read_b64_tr_b16 v[128:129], v5 offset:4096
    ds_read_b64_tr_b16 v[130:131], v5 offset:5120
    ds_read_b64_tr_b16 v[132:133], v6 offset:4096
    ds_read_b64_tr_b16 v[134:135], v6 offset:5120
    s_waitcnt lgkmcnt(4)
    v_mfma_f32_32x32x16_bf16 v[144:159], v[136:139], v[24:27], v[144:159]
    v_mfma_f32_32x32x16_bf16 v[160:175], v[136:139], v[28:31], v[160:175]
    v_mfma_f32_32x32x16_bf16 v[176:191], v[140:143], v[24:27], v[176:191]
    v_mfma_f32_32x32x16_bf16 v[192:207], v[140:143], v[28:31], v[192:207]
    s_mov_b32 s80, 215040
    s_mov_b32 s81, 222208
    s_mov_b32 s82, 15360
    s_mov_b32 s83, 130048
    s_add_u32 m0, s78, 14336
    s_nop 0
    buffer_load_dwordx4 v3, s[8:11], s80 offen lds
    s_add_u32 m0, s78, 15360
    s_nop 0
    buffer_load_dwordx4 v3, s[8:11], s81 offen lds
    buffer_load_dwordx4 v[72:75], v4, s[20:23], s82 offen
    buffer_load_dwordx4 v[76:79], v4, s[20:23], s83 offen
    v_lshlrev_b32 v7, 4, v1
    v_and_b32 v12, 31, v1
    v_lshrrev_b32 v13, 5, v1
    s_lshl_b32 s80, s75, 6
    v_add_u32 v208, s80, v12
    v_cvt_f32_u32 v208, v208
    v_mul_f32 v208, 0x3b124925, v208
    v_add_f32 v209, 0x3d924925, v208
    s_and_b32 s80, s36, 3
    s_lshl_b32 s80, s80, 6
    v_lshlrev_b32 v210, 3, v13
    v_add_u32 v210, s80, v210
    v_cvt_f32_u32 v210, v210
    s_cmp_ge_u32 s36, 4
    s_cselect_b32 s81, 0x3e800000, 0
    s_cselect_b32 s82, 0, 0.5
    v_mov_b32 v211, s81
    v_mov_b32 v212, s82
    v_fma_f32 v213, v210, v208, v211
    v_fma_f32 v214, v210, v209, v211
    v_cos_f32 v215, v208
    v_cos_f32 v216, v209
    v_add_f32 v215, v215, v215
    v_add_f32 v216, v216, v216
    v_mov_b32 v217, 0x43600000
    v_mov_b32 v218, 0
    v_mov_b32 v219, 1.0
    v_add_f32 v236, 0x00000000, v210
    v_cmp_lt_f32 vcc, v217, v236
    s_nop 1
    v_cndmask_b32 v228, v219, v218, vcc
    v_cmp_eq_f32 vcc, v217, v236
    s_nop 1
    v_cndmask_b32 v228, v228, v212, vcc
    v_cmp_eq_f32 vcc, 0, v236
    s_nop 1
    v_cndmask_b32 v228, v228, v212, vcc
    v_fmamk_f32 v220, v208, 0x00000000, v213
    v_fmamk_f32 v221, v208, 0x3f800000, v213
    v_cos_f32 v220, v220
    v_cos_f32 v221, v221
    s_nop 0
    v_fma_f32 v222, v215, v221, -v220
    v_fma_f32 v223, v215, v222, -v221
    v_fma_f32 v224, v215, v223, -v222
    v_fma_f32 v225, v215, v224, -v223
    v_fma_f32 v226, v215, v225, -v224
    v_fma_f32 v227, v215, v226, -v225
    v_mul_f32 v220, v220, v228
    v_cvt_pk_bf16_f32 v96, v220, v221
    v_cvt_pk_bf16_f32 v97, v222, v223
    v_cvt_pk_bf16_f32 v98, v224, v225
    v_cvt_pk_bf16_f32 v99, v226, v227
    v_fmamk_f32 v220, v209, 0x00000000, v214
    v_fmamk_f32 v221, v209, 0x3f800000, v214
    v_cos_f32 v220, v220
    v_cos_f32 v221, v221
    s_nop 0
    v_fma_f32 v222, v216, v221, -v220
    v_fma_f32 v223, v216, v222, -v221
    v_fma_f32 v224, v216, v223, -v222
    v_fma_f32 v225, v216, v224, -v223
    v_fma_f32 v226, v216, v225, -v224
    v_fma_f32 v227, v216, v226, -v225
    v_mul_f32 v220, v220, v228
    v_cvt_pk_bf16_f32 v112, v220, v221
    v_cvt_pk_bf16_f32 v113, v222, v223
    v_cvt_pk_bf16_f32 v114, v224, v225
    v_cvt_pk_bf16_f32 v115, v226, v227
    v_fmamk_f32 v220, v208, 0x41800000, v213
    v_fmamk_f32 v221, v208, 0x41880000, v213
    v_cos_f32 v220, v220
    v_cos_f32 v221, v221
    s_nop 0
    v_fma_f32 v222, v215, v221, -v220
    v_fma_f32 v223, v215, v222, -v221
    v_fma_f32 v224, v215, v223, -v222
    v_fma_f32 v225, v215, v224, -v223
    v_fma_f32 v226, v215, v225, -v224
    v_fma_f32 v227, v215, v226, -v225
    v_cvt_pk_bf16_f32 v100, v220, v221
    v_cvt_pk_bf16_f32 v101, v222, v223
    v_cvt_pk_bf16_f32 v102, v224, v225
    v_cvt_pk_bf16_f32 v103, v226, v227
    v_fmamk_f32 v220, v209, 0x41800000, v214
    v_fmamk_f32 v221, v209, 0x41880000, v214
    v_cos_f32 v220, v220
    v_cos_f32 v221, v221
    s_nop 0
    v_fma_f32 v222, v216, v221, -v220
    v_fma_f32 v223, v216, v222, -v221
    v_fma_f32 v224, v216, v223, -v222
    v_fma_f32 v225, v216, v224, -v223
    v_fma_f32 v226, v216, v225, -v224
    v_fma_f32 v227, v216, v226, -v225
    v_cvt_pk_bf16_f32 v116, v220, v221
    v_cvt_pk_bf16_f32 v117, v222, v223
    v_cvt_pk_bf16_f32 v118, v224, v225
    v_cvt_pk_bf16_f32 v119, v226, v227
    v_add_f32 v236, 0x42000000, v210
    v_cmp_lt_f32 vcc, v217, v236
    s_nop 1
    v_cndmask_b32 v228, v219, v218, vcc
    v_cmp_eq_f32 vcc, v217, v236
    s_nop 1
    v_cndmask_b32 v228, v228, v212, vcc
    v_cmp_eq_f32 vcc, 0, v236
    s_nop 1
    v_cndmask_b32 v228, v228, v212, vcc
    v_add_f32 v236, 0x42040000, v210
    v_cmp_lt_f32 vcc, v217, v236
    s_nop 1
    v_cndmask_b32 v229, v219, v218, vcc
    v_cmp_eq_f32 vcc, v217, v236
    s_nop 1
    v_cndmask_b32 v229, v229, v212, vcc
    v_cmp_eq_f32 vcc, 0, v236
    s_nop 1
    v_cndmask_b32 v229, v229, v212, vcc
    v_add_f32 v236, 0x42080000, v210
    v_cmp_lt_f32 vcc, v217, v236
    s_nop 1
    v_cndmask_b32 v230, v219, v218, vcc
    v_cmp_eq_f32 vcc, v217, v236
    s_nop 1
    v_cndmask_b32 v230, v230, v212, vcc
    v_cmp_eq_f32 vcc, 0, v236
    s_nop 1
    v_cndmask_b32 v230, v230, v212, vcc
    v_add_f32 v236, 0x420c0000, v210
    v_cmp_lt_f32 vcc, v217, v236
    s_nop 1
    v_cndmask_b32 v231, v219, v218, vcc
    v_cmp_eq_f32 vcc, v217, v236
    s_nop 1
    v_cndmask_b32 v231, v231, v212, vcc
    v_cmp_eq_f32 vcc, 0, v236
    s_nop 1
    v_cndmask_b32 v231, v231, v212, vcc
    v_add_f32 v236, 0x42100000, v210
    v_cmp_lt_f32 vcc, v217, v236
    s_nop 1
    v_cndmask_b32 v232, v219, v218, vcc
    v_cmp_eq_f32 vcc, v217, v236
    s_nop 1
    v_cndmask_b32 v232, v232, v212, vcc
    v_cmp_eq_f32 vcc, 0, v236
    s_nop 1
    v_cndmask_b32 v232, v232, v212, vcc
    v_add_f32 v236, 0x42140000, v210
    v_cmp_lt_f32 vcc, v217, v236
    s_nop 1
    v_cndmask_b32 v233, v219, v218, vcc
    v_cmp_eq_f32 vcc, v217, v236
    s_nop 1
    v_cndmask_b32 v233, v233, v212, vcc
    v_cmp_eq_f32 vcc, 0, v236
    s_nop 1
    v_cndmask_b32 v233, v233, v212, vcc
    v_add_f32 v236, 0x42180000, v210
    v_cmp_lt_f32 vcc, v217, v236
    s_nop 1
    v_cndmask_b32 v234, v219, v218, vcc
    v_cmp_eq_f32 vcc, v217, v236
    s_nop 1
    v_cndmask_b32 v234, v234, v212, vcc
    v_cmp_eq_f32 vcc, 0, v236
    s_nop 1
    v_cndmask_b32 v234, v234, v212, vcc
    v_add_f32 v236, 0x421c0000, v210
    v_cmp_lt_f32 vcc, v217, v236
    s_nop 1
    v_cndmask_b32 v235, v219, v218, vcc
    v_cmp_eq_f32 vcc, v217, v236
    s_nop 1
    v_cndmask_b32 v235, v235, v212, vcc
    v_cmp_eq_f32 vcc, 0, v236
    s_nop 1
    v_cndmask_b32 v235, v235, v212, vcc
    v_fmamk_f32 v220, v208, 0x42000000, v213
    v_fmamk_f32 v221, v208, 0x42040000, v213
    v_cos_f32 v220, v220
    v_cos_f32 v221, v221
    s_nop 0
    v_fma_f32 v222, v215, v221, -v220
    v_fma_f32 v223, v215, v222, -v221
    v_fma_f32 v224, v215, v223, -v222
    v_fma_f32 v225, v215, v224, -v223
    v_fma_f32 v226, v215, v225, -v224
    v_fma_f32 v227, v215, v226, -v225
    v_mul_f32 v220, v220, v228
    v_mul_f32 v221, v221, v229
    v_mul_f32 v222, v222, v230
    v_mul_f32 v223, v223, v231
    v_mul_f32 v224, v224, v232
    v_mul_f32 v225, v225, v233
    v_mul_f32 v226, v226, v234
    v_mul_f32 v227, v227, v235
    v_cvt_pk_bf16_f32 v104, v220, v221
    v_cvt_pk_bf16_f32 v105, v222, v223
    v_cvt_pk_bf16_f32 v106, v224, v225
    v_cvt_pk_bf16_f32 v107, v226, v227
    v_fmamk_f32 v220, v209, 0x42000000, v214
    v_fmamk_f32 v221, v209, 0x42040000, v214
    v_cos_f32 v220, v220
    v_cos_f32 v221, v221
    s_nop 0
    v_fma_f32 v222, v216, v221, -v220
    v_fma_f32 v223, v216, v222, -v221
    v_fma_f32 v224, v216, v223, -v222
    v_fma_f32 v225, v216, v224, -v223
    v_fma_f32 v226, v216, v225, -v224
    v_fma_f32 v227, v216, v226, -v225
    v_mul_f32 v220, v220, v228
    v_mul_f32 v221, v221, v229
    v_mul_f32 v222, v222, v230
    v_mul_f32 v223, v223, v231
    v_mul_f32 v224, v224, v232
    v_mul_f32 v225, v225, v233
    v_mul_f32 v226, v226, v234
    v_mul_f32 v227, v227, v235
    v_cvt_pk_bf16_f32 v120, v220, v221
    v_cvt_pk_bf16_f32 v121, v222, v223
    v_cvt_pk_bf16_f32 v122, v224, v225
    v_cvt_pk_bf16_f32 v123, v226, v227
    v_add_f32 v236, 0x42400000, v210
    v_cmp_lt_f32 vcc, v217, v236
    s_nop 1
    v_cndmask_b32 v228, v219, v218, vcc
    v_cmp_eq_f32 vcc, v217, v236
    s_nop 1
    v_cndmask_b32 v228, v228, v212, vcc
    v_cmp_eq_f32 vcc, 0, v236
    s_nop 1
    v_cndmask_b32 v228, v228, v212, vcc
    v_add_f32 v236, 0x42440000, v210
    v_cmp_lt_f32 vcc, v217, v236
    s_nop 1
    v_cndmask_b32 v229, v219, v218, vcc
    v_cmp_eq_f32 vcc, v217, v236
    s_nop 1
    v_cndmask_b32 v229, v229, v212, vcc
    v_cmp_eq_f32 vcc, 0, v236
    s_nop 1
    v_cndmask_b32 v229, v229, v212, vcc
    v_add_f32 v236, 0x42480000, v210
    v_cmp_lt_f32 vcc, v217, v236
    s_nop 1
    v_cndmask_b32 v230, v219, v218, vcc
    v_cmp_eq_f32 vcc, v217, v236
    s_nop 1
    v_cndmask_b32 v230, v230, v212, vcc
    v_cmp_eq_f32 vcc, 0, v236
    s_nop 1
    v_cndmask_b32 v230, v230, v212, vcc
    v_add_f32 v236, 0x424c0000, v210
    v_cmp_lt_f32 vcc, v217, v236
    s_nop 1
    v_cndmask_b32 v231, v219, v218, vcc
    v_cmp_eq_f32 vcc, v217, v236
    s_nop 1
    v_cndmask_b32 v231, v231, v212, vcc
    v_cmp_eq_f32 vcc, 0, v236
    s_nop 1
    v_cndmask_b32 v231, v231, v212, vcc
    v_add_f32 v236, 0x42500000, v210
    v_cmp_lt_f32 vcc, v217, v236
    s_nop 1
    v_cndmask_b32 v232, v219, v218, vcc
    v_cmp_eq_f32 vcc, v217, v236
    s_nop 1
    v_cndmask_b32 v232, v232, v212, vcc
    v_cmp_eq_f32 vcc, 0, v236
    s_nop 1
    v_cndmask_b32 v232, v232, v212, vcc
    v_add_f32 v236, 0x42540000, v210
    v_cmp_lt_f32 vcc, v217, v236
    s_nop 1
    v_cndmask_b32 v233, v219, v218, vcc
    v_cmp_eq_f32 vcc, v217, v236
    s_nop 1
    v_cndmask_b32 v233, v233, v212, vcc
    v_cmp_eq_f32 vcc, 0, v236
    s_nop 1
    v_cndmask_b32 v233, v233, v212, vcc
    v_add_f32 v236, 0x42580000, v210
    v_cmp_lt_f32 vcc, v217, v236
    s_nop 1
    v_cndmask_b32 v234, v219, v218, vcc
    v_cmp_eq_f32 vcc, v217, v236
    s_nop 1
    v_cndmask_b32 v234, v234, v212, vcc
    v_cmp_eq_f32 vcc, 0, v236
    s_nop 1
    v_cndmask_b32 v234, v234, v212, vcc
    v_add_f32 v236, 0x425c0000, v210
    v_cmp_lt_f32 vcc, v217, v236
    s_nop 1
    v_cndmask_b32 v235, v219, v218, vcc
    v_cmp_eq_f32 vcc, v217, v236
    s_nop 1
    v_cndmask_b32 v235, v235, v212, vcc
    v_cmp_eq_f32 vcc, 0, v236
    s_nop 1
    v_cndmask_b32 v235, v235, v212, vcc
    v_fmamk_f32 v220, v208, 0x42400000, v213
    v_fmamk_f32 v221, v208, 0x42440000, v213
    v_cos_f32 v220, v220
    v_cos_f32 v221, v221
    s_nop 0
    v_fma_f32 v222, v215, v221, -v220
    v_fma_f32 v223, v215, v222, -v221
    v_fma_f32 v224, v215, v223, -v222
    v_fma_f32 v225, v215, v224, -v223
    v_fma_f32 v226, v215, v225, -v224
    v_fma_f32 v227, v215, v226, -v225
    v_mul_f32 v220, v220, v228
    v_mul_f32 v221, v221, v229
    v_mul_f32 v222, v222, v230
    v_mul_f32 v223, v223, v231
    v_mul_f32 v224, v224, v232
    v_mul_f32 v225, v225, v233
    v_mul_f32 v226, v226, v234
    v_mul_f32 v227, v227, v235
    v_cvt_pk_bf16_f32 v108, v220, v221
    v_cvt_pk_bf16_f32 v109, v222, v223
    v_cvt_pk_bf16_f32 v110, v224, v225
    v_cvt_pk_bf16_f32 v111, v226, v227
    v_fmamk_f32 v220, v209, 0x42400000, v214
    v_fmamk_f32 v221, v209, 0x42440000, v214
    v_cos_f32 v220, v220
    v_cos_f32 v221, v221
    s_nop 0
    v_fma_f32 v222, v216, v221, -v220
    v_fma_f32 v223, v216, v222, -v221
    v_fma_f32 v224, v216, v223, -v222
    v_fma_f32 v225, v216, v224, -v223
    v_fma_f32 v226, v216, v225, -v224
    v_fma_f32 v227, v216, v226, -v225
    v_mul_f32 v220, v220, v228
    v_mul_f32 v221, v221, v229
    v_mul_f32 v222, v222, v230
    v_mul_f32 v223, v223, v231
    v_mul_f32 v224, v224, v232
    v_mul_f32 v225, v225, v233
    v_mul_f32 v226, v226, v234
    v_mul_f32 v227, v227, v235
    v_cvt_pk_bf16_f32 v124, v220, v221
    v_cvt_pk_bf16_f32 v125, v222, v223
    v_cvt_pk_bf16_f32 v126, v224, v225
    v_cvt_pk_bf16_f32 v127, v226, v227
    s_and_b32 s83, s36, 3
    s_lshl_b32 s83, s83, 6
    v_lshrrev_b32 v8, 3, v1
    v_add_u32 v8, s83, v8
    v_lshrrev_b32 v10, 4, v1
    v_and_b32 v10, 1, v10
    v_lshlrev_b32 v10, 2, v10
    v_and_b32 v11, 7, v1
    v_xor_b32 v10, v11, v10
    v_lshlrev_b32 v10, 4, v10
    s_lshr_b32 s84, s36, 2
    s_mul_i32 s84, s84, 921600
    s_lshl_b32 s85, s74, 7
    s_add_u32 s84, s84, s85
    s_add_u32 s84, s84, 0xc00000
    v_mov_b32 v15, 224
    s_mov_b32 s85, 0xb85800
    v_add_u32 v9, 0, v8
    v_min_u32 v9, v9, v15
    v_lshl_add_u32 v82, v9, 12, v10
    v_add_u32 v9, 8, v8
    v_min_u32 v9, v9, v15
    v_lshl_add_u32 v83, v9, 12, v10
    v_add_u32 v9, 16, v8
    v_min_u32 v9, v9, v15
    v_lshl_add_u32 v84, v9, 12, v10
    v_add_u32 v9, 24, v8
    v_min_u32 v9, v9, v15
    v_lshl_add_u32 v85, v9, 12, v10
    v_add_u32 v9, 32, v8
    v_min_u32 v9, v9, v15
    v_lshl_add_u32 v86, v9, 12, v10
    v_add_u32 v9, 40, v8
    v_min_u32 v9, v9, v15
    v_lshl_add_u32 v87, v9, 12, v10
    v_add_u32 v9, 48, v8
    v_min_u32 v9, v9, v15
    v_lshl_add_u32 v88, v9, 12, v10
    v_add_u32 v9, 56, v8
    v_min_u32 v9, v9, v15
    v_lshl_add_u32 v89, v9, 12, v10
    v_and_b32 v8, 15, v1
    v_lshrrev_b32 v9, 2, v8
    v_lshrrev_b32 v10, 5, v1
    v_lshl_add_u32 v9, v10, 3, v9
    v_lshlrev_b32 v9, 7, v9
    v_lshrrev_b32 v10, 4, v1
    v_and_b32 v10, 1, v10
    v_lshlrev_b32 v10, 1, v10
    v_lshrrev_b32 v11, 1, v8
    v_and_b32 v11, 1, v11
    v_add_u32 v10, v10, v11
    v_add_u32 v10, 0, v10
    v_lshrrev_b32 v11, 3, v8
    v_lshlrev_b32 v11, 2, v11
    v_xor_b32 v10, v10, v11
    v_lshl_add_u32 v9, v10, 4, v9
    v_and_b32 v11, 1, v8
    v_lshl_add_u32 v90, v11, 3, v9
    v_add_u32 v90, s78, v90
    v_xor_b32 v91, 64, v90
    s_waitcnt vmcnt(16)
    ds_read_b64_tr_b16 v[136:137], v5 offset:6144
    ds_read_b64_tr_b16 v[138:139], v5 offset:7168
    ds_read_b64_tr_b16 v[140:141], v6 offset:6144
    ds_read_b64_tr_b16 v[142:143], v6 offset:7168
    s_waitcnt lgkmcnt(4)
    v_mfma_f32_32x32x16_bf16 v[144:159], v[128:131], v[32:35], v[144:159]
    v_mfma_f32_32x32x16_bf16 v[160:175], v[128:131], v[36:39], v[160:175]
    v_mfma_f32_32x32x16_bf16 v[176:191], v[132:135], v[32:35], v[176:191]
    v_mfma_f32_32x32x16_bf16 v[192:207], v[132:135], v[36:39], v[192:207]
    s_waitcnt vmcnt(12)
    ds_read_b64_tr_b16 v[128:129], v5 offset:8192
    ds_read_b64_tr_b16 v[130:131], v5 offset:9216
    ds_read_b64_tr_b16 v[132:133], v6 offset:8192
    ds_read_b64_tr_b16 v[134:135], v6 offset:9216
    s_waitcnt lgkmcnt(4)
    v_mfma_f32_32x32x16_bf16 v[144:159], v[136:139], v[40:43], v[144:159]
    v_mfma_f32_32x32x16_bf16 v[160:175], v[136:139], v[44:47], v[160:175]
    v_mfma_f32_32x32x16_bf16 v[176:191], v[140:143], v[40:43], v[176:191]
    v_mfma_f32_32x32x16_bf16 v[192:207], v[140:143], v[44:47], v[192:207]
    s_waitcnt vmcnt(8)
    ds_read_b64_tr_b16 v[136:137], v5 offset:10240
    ds_read_b64_tr_b16 v[138:139], v5 offset:11264
    ds_read_b64_tr_b16 v[140:141], v6 offset:10240
    ds_read_b64_tr_b16 v[142:143], v6 offset:11264
    s_waitcnt lgkmcnt(4)
    v_mfma_f32_32x32x16_bf16 v[144:159], v[128:131], v[48:51], v[144:159]
    v_mfma_f32_32x32x16_bf16 v[160:175], v[128:131], v[52:55], v[160:175]
    v_mfma_f32_32x32x16_bf16 v[176:191], v[132:135], v[48:51], v[176:191]
    v_mfma_f32_32x32x16_bf16 v[192:207], v[132:135], v[52:55], v[192:207]
    s_waitcnt vmcnt(4)
    ds_read_b64_tr_b16 v[128:129], v5 offset:12288
    ds_read_b64_tr_b16 v[130:131], v5 offset:13312
    ds_read_b64_tr_b16 v[132:133], v6 offset:12288
    ds_read_b64_tr_b16 v[134:135], v6 offset:13312
    s_waitcnt lgkmcnt(4)
    v_mfma_f32_32x32x16_bf16 v[144:159], v[136:139], v[56:59], v[144:159]
    v_mfma_f32_32x32x16_bf16 v[160:175], v[136:139], v[60:63], v[160:175]
    v_mfma_f32_32x32x16_bf16 v[176:191], v[140:143], v[56:59], v[176:191]
    v_mfma_f32_32x32x16_bf16 v[192:207], v[140:143], v[60:63], v[192:207]
    s_waitcnt vmcnt(0)
    ds_read_b64_tr_b16 v[136:137], v5 offset:14336
    ds_read_b64_tr_b16 v[138:139], v5 offset:15360
    ds_read_b64_tr_b16 v[140:141], v6 offset:14336
    ds_read_b64_tr_b16 v[142:143], v6 offset:15360
    s_waitcnt lgkmcnt(4)
    v_mfma_f32_32x32x16_bf16 v[144:159], v[128:131], v[64:67], v[144:159]
    v_mfma_f32_32x32x16_bf16 v[160:175], v[128:131], v[68:71], v[160:175]
    v_mfma_f32_32x32x16_bf16 v[176:191], v[132:135], v[64:67], v[176:191]
    v_mfma_f32_32x32x16_bf16 v[192:207], v[132:135], v[68:71], v[192:207]
    s_waitcnt lgkmcnt(0)
    v_mfma_f32_32x32x16_bf16 v[144:159], v[136:139], v[72:75], v[144:159]
    v_mfma_f32_32x32x16_bf16 v[160:175], v[136:139], v[76:79], v[160:175]
    v_mfma_f32_32x32x16_bf16 v[176:191], v[140:143], v[72:75], v[176:191]
    v_mfma_f32_32x32x16_bf16 v[192:207], v[140:143], v[76:79], v[192:207]
K2_TAIL:
    s_cmp_lg_u32 s36, 7
    s_cbranch_scc1 K2_GO
    v_lshlrev_b32 v228, 8, v1
K2_POLL:
    buffer_load_dword v224, v228, s[20:23], s85 offen sc1
    buffer_load_dword v225, v228, s[20:23], s85 offen offset:64 sc1
    buffer_load_dword v226, v228, s[20:23], s85 offen offset:128 sc1
    buffer_load_dword v227, v228, s[20:23], s85 offen offset:192 sc1
    s_waitcnt vmcnt(0)
    v_and_b32 v224, v224, v225
    v_and_b32 v226, v226, v227
    v_and_b32 v224, v224, v226
    v_cmp_eq_u32 vcc, 1, v224
    s_nop 1
    s_cmp_eq_u64 vcc, exec
    s_cbranch_scc1 K2_GO
    s_sleep 4
    s_branch K2_POLL
K2_GO:
    v_mul_f32 v144, v144, v92
    v_mul_f32 v145, v145, v92
    v_mul_f32 v146, v146, v92
    v_mul_f32 v147, v147, v92
    v_mul_f32 v148, v148, v92
    v_mul_f32 v149, v149, v92
    v_mul_f32 v150, v150, v92
    v_mul_f32 v151, v151, v92
    v_mul_f32 v152, v152, v92
    v_mul_f32 v153, v153, v92
    v_mul_f32 v154, v154, v92
    v_mul_f32 v155, v155, v92
    v_mul_f32 v156, v156, v92
    v_mul_f32 v157, v157, v92
    v_mul_f32 v158, v158, v92
    v_mul_f32 v159, v159, v92
    v_mul_f32 v160, v160, v93
    v_mul_f32 v161, v161, v93
    v_mul_f32 v162, v162, v93
    v_mul_f32 v163, v163, v93
    v_mul_f32 v164, v164, v93
    v_mul_f32 v165, v165, v93
    v_mul_f32 v166, v166, v93
    v_mul_f32 v167, v167, v93
    v_mul_f32 v168, v168, v93
    v_mul_f32 v169, v169, v93
    v_mul_f32 v170, v170, v93
    v_mul_f32 v171, v171, v93
    v_mul_f32 v172, v172, v93
    v_mul_f32 v173, v173, v93
    v_mul_f32 v174, v174, v93
    v_mul_f32 v175, v175, v93
    v_mul_f32 v176, v176, v92
    v_mul_f32 v177, v177, v92
    v_mul_f32 v178, v178, v92
    v_mul_f32 v179, v179, v92
    v_mul_f32 v180, v180, v92
    v_mul_f32 v181, v181, v92
    v_mul_f32 v182, v182, v92
    v_mul_f32 v183, v183, v92
    v_mul_f32 v184, v184, v92
    v_mul_f32 v185, v185, v92
    v_mul_f32 v186, v186, v92
    v_mul_f32 v187, v187, v92
    v_mul_f32 v188, v188, v92
    v_mul_f32 v189, v189, v92
    v_mul_f32 v190, v190, v92
    v_mul_f32 v191, v191, v92
    v_mul_f32 v192, v192, v93
    v_mul_f32 v193, v193, v93
    v_mul_f32 v194, v194, v93
    v_mul_f32 v195, v195, v93
    v_mul_f32 v196, v196, v93
    v_mul_f32 v197, v197, v93
    v_mul_f32 v198, v198, v93
    v_mul_f32 v199, v199, v93
    v_mul_f32 v200, v200, v93
    v_mul_f32 v201, v201, v93
    v_mul_f32 v202, v202, v93
    v_mul_f32 v203, v203, v93
    v_mul_f32 v204, v204, v93
    v_mul_f32 v205, v205, v93
    v_mul_f32 v206, v206, v93
    v_mul_f32 v207, v207, v93
    s_barrier
    s_add_u32 m0, s78, 0
    s_nop 0
    buffer_load_dwordx4 v82, s[20:23], s84 offen sc0 sc1 lds
    s_add_u32 m0, s78, 1024
    s_nop 0
    buffer_load_dwordx4 v83, s[20:23], s84 offen sc0 sc1 lds
    s_add_u32 m0, s78, 2048
    s_nop 0
    buffer_load_dwordx4 v84, s[20:23], s84 offen sc0 sc1 lds
    s_add_u32 m0, s78, 3072
    s_nop 0
    buffer_load_dwordx4 v85, s[20:23], s84 offen sc0 sc1 lds
    s_add_u32 m0, s78, 4096
    s_nop 0
    buffer_load_dwordx4 v86, s[20:23], s84 offen sc0 sc1 lds
    s_add_u32 m0, s78, 5120
    s_nop 0
    buffer_load_dwordx4 v87, s[20:23], s84 offen sc0 sc1 lds
    s_add_u32 m0, s78, 6144
    s_nop 0
    buffer_load_dwordx4 v88, s[20:23], s84 offen sc0 sc1 lds
    s_add_u32 m0, s78, 7168
    s_nop 0
    buffer_load_dwordx4 v89, s[20:23], s84 offen sc0 sc1 lds
    s_waitcnt vmcnt(6)
    ds_read_b64_tr_b16 v[128:129], v90 offset:0
    ds_read_b64_tr_b16 v[130:131], v90 offset:512
    ds_read_b64_tr_b16 v[132:133], v91 offset:0
    ds_read_b64_tr_b16 v[134:135], v91 offset:512
    s_waitcnt vmcnt(4)
    ds_read_b64_tr_b16 v[136:137], v90 offset:2048
    ds_read_b64_tr_b16 v[138:139], v90 offset:2560
    ds_read_b64_tr_b16 v[140:141], v91 offset:2048
    ds_read_b64_tr_b16 v[142:143], v91 offset:2560
    s_waitcnt vmcnt(2)
    ds_read_b64_tr_b16 v[208:209], v90 offset:4096
    ds_read_b64_tr_b16 v[210:211], v90 offset:4608
    ds_read_b64_tr_b16 v[212:213], v91 offset:4096
    ds_read_b64_tr_b16 v[214:215], v91 offset:4608
    s_waitcnt vmcnt(0)
    ds_read_b64_tr_b16 v[216:217], v90 offset:6144
    ds_read_b64_tr_b16 v[218:219], v90 offset:6656
    ds_read_b64_tr_b16 v[220:221], v91 offset:6144
    ds_read_b64_tr_b16 v[222:223], v91 offset:6656
    s_waitcnt lgkmcnt(12)
    v_mfma_f32_32x32x16_bf16 v[16:31], v[96:99], v[128:131], 0
    v_mfma_f32_32x32x16_bf16 v[32:47], v[96:99], v[132:135], 0
    v_mfma_f32_32x32x16_bf16 v[48:63], v[112:115], v[128:131], 0
    v_mfma_f32_32x32x16_bf16 v[64:79], v[112:115], v[132:135], 0
    s_waitcnt lgkmcnt(8)
    v_mfma_f32_32x32x16_bf16 v[16:31], v[100:103], v[136:139], v[16:31]
    v_mfma_f32_32x32x16_bf16 v[32:47], v[100:103], v[140:143], v[32:47]
    v_mfma_f32_32x32x16_bf16 v[48:63], v[116:119], v[136:139], v[48:63]
    v_mfma_f32_32x32x16_bf16 v[64:79], v[116:119], v[140:143], v[64:79]
    s_waitcnt lgkmcnt(4)
    v_mfma_f32_32x32x16_bf16 v[16:31], v[104:107], v[208:211], v[16:31]
    v_mfma_f32_32x32x16_bf16 v[32:47], v[104:107], v[212:215], v[32:47]
    v_mfma_f32_32x32x16_bf16 v[48:63], v[120:123], v[208:211], v[48:63]
    v_mfma_f32_32x32x16_bf16 v[64:79], v[120:123], v[212:215], v[64:79]
    s_waitcnt lgkmcnt(0)
    v_mfma_f32_32x32x16_bf16 v[16:31], v[108:111], v[216:219], v[16:31]
    v_mfma_f32_32x32x16_bf16 v[32:47], v[108:111], v[220:223], v[32:47]
    v_mfma_f32_32x32x16_bf16 v[48:63], v[124:127], v[216:219], v[48:63]
    v_mfma_f32_32x32x16_bf16 v[64:79], v[124:127], v[220:223], v[64:79]
    s_nop 8
    v_fma_f32 v144, v16, v80, v144
    v_fma_f32 v145, v17, v80, v145
    v_fma_f32 v146, v18, v80, v146
    v_fma_f32 v147, v19, v80, v147
    v_fma_f32 v148, v20, v80, v148
    v_fma_f32 v149, v21, v80, v149
    v_fma_f32 v150, v22, v80, v150
    v_fma_f32 v151, v23, v80, v151
    v_fma_f32 v152, v24, v80, v152
    v_fma_f32 v153, v25, v80, v153
    v_fma_f32 v154, v26, v80, v154
    v_fma_f32 v155, v27, v80, v155
    v_fma_f32 v156, v28, v80, v156
    v_fma_f32 v157, v29, v80, v157
    v_fma_f32 v158, v30, v80, v158
    v_fma_f32 v159, v31, v80, v159
    v_fma_f32 v160, v32, v81, v160
    v_fma_f32 v161, v33, v81, v161
    v_fma_f32 v162, v34, v81, v162
    v_fma_f32 v163, v35, v81, v163
    v_fma_f32 v164, v36, v81, v164
    v_fma_f32 v165, v37, v81, v165
    v_fma_f32 v166, v38, v81, v166
    v_fma_f32 v167, v39, v81, v167
    v_fma_f32 v168, v40, v81, v168
    v_fma_f32 v169, v41, v81, v169
    v_fma_f32 v170, v42, v81, v170
    v_fma_f32 v171, v43, v81, v171
    v_fma_f32 v172, v44, v81, v172
    v_fma_f32 v173, v45, v81, v173
    v_fma_f32 v174, v46, v81, v174
    v_fma_f32 v175, v47, v81, v175
    v_fma_f32 v176, v48, v80, v176
    v_fma_f32 v177, v49, v80, v177
    v_fma_f32 v178, v50, v80, v178
    v_fma_f32 v179, v51, v80, v179
    v_fma_f32 v180, v52, v80, v180
    v_fma_f32 v181, v53, v80, v181
    v_fma_f32 v182, v54, v80, v182
    v_fma_f32 v183, v55, v80, v183
    v_fma_f32 v184, v56, v80, v184
    v_fma_f32 v185, v57, v80, v185
    v_fma_f32 v186, v58, v80, v186
    v_fma_f32 v187, v59, v80, v187
    v_fma_f32 v188, v60, v80, v188
    v_fma_f32 v189, v61, v80, v189
    v_fma_f32 v190, v62, v80, v190
    v_fma_f32 v191, v63, v80, v191
    v_fma_f32 v192, v64, v81, v192
    v_fma_f32 v193, v65, v81, v193
    v_fma_f32 v194, v66, v81, v194
    v_fma_f32 v195, v67, v81, v195
    v_fma_f32 v196, v68, v81, v196
    v_fma_f32 v197, v69, v81, v197
    v_fma_f32 v198, v70, v81, v198
    v_fma_f32 v199, v71, v81, v199
    v_fma_f32 v200, v72, v81, v200
    v_fma_f32 v201, v73, v81, v201
    v_fma_f32 v202, v74, v81, v202
    v_fma_f32 v203, v75, v81, v203
    v_fma_f32 v204, v76, v81, v204
    v_fma_f32 v205, v77, v81, v205
    v_fma_f32 v206, v78, v81, v206
    v_fma_f32 v207, v79, v81, v207
    v_add_u32 v8, s78, v7
    s_lshl_b32 s79, s36, 11
    v_add_u32 v9, s79, v7
    v_add_u32 v10, 65536, v9
    ds_write_b128 v8, v[144:147] offset:0
    ds_write_b128 v8, v[148:151] offset:1024
    ds_write_b128 v8, v[152:155] offset:2048
    ds_write_b128 v8, v[156:159] offset:3072
    ds_write_b128 v8, v[160:163] offset:4096
    ds_write_b128 v8, v[164:167] offset:5120
    ds_write_b128 v8, v[168:171] offset:6144
    ds_write_b128 v8, v[172:175] offset:7168
    ds_write_b128 v8, v[176:179] offset:8192
    ds_write_b128 v8, v[180:183] offset:9216
    ds_write_b128 v8, v[184:187] offset:10240
    ds_write_b128 v8, v[188:191] offset:11264
    ds_write_b128 v8, v[192:195] offset:12288
    ds_write_b128 v8, v[196:199] offset:13312
    ds_write_b128 v8, v[200:203] offset:14336
    ds_write_b128 v8, v[204:207] offset:15360
    s_waitcnt lgkmcnt(0)
    s_barrier
    ds_read_b128 v[16:19], v9 offset:0
    ds_read_b128 v[20:23], v9 offset:1024
    ds_read_b128 v[24:27], v9 offset:16384
    ds_read_b128 v[28:31], v9 offset:17408
    ds_read_b128 v[32:35], v9 offset:32768
    ds_read_b128 v[36:39], v9 offset:33792
    ds_read_b128 v[40:43], v9 offset:49152
    ds_read_b128 v[44:47], v9 offset:50176
    ds_read_b128 v[48:51], v10 offset:0
    ds_read_b128 v[52:55], v10 offset:1024
    ds_read_b128 v[56:59], v10 offset:16384
    ds_read_b128 v[60:63], v10 offset:17408
    ds_read_b128 v[64:67], v10 offset:32768
    ds_read_b128 v[68:71], v10 offset:33792
    ds_read_b128 v[72:75], v10 offset:49152
    ds_read_b128 v[76:79], v10 offset:50176
    s_lshr_b32 s80, s36, 1
    s_and_b32 s81, s80, 1
    s_lshr_b32 s80, s80, 1
    s_lshl_b32 s82, s74, 1
    s_add_u32 s82, s82, s81
    s_mul_i32 s82, s82, 896
    s_lshl_b32 s83, s75, 1
    s_add_u32 s83, s83, s80
    s_lshl_b32 s83, s83, 6
    s_add_u32 s82, s82, s83
    s_and_b32 s83, s36, 1
    s_lshl_b32 s83, s83, 5
    s_add_u32 s82, s82, s83
    v_mul_u32_u24 v11, 57344, v12
    v_lshl_add_u32 v11, v13, 4, v11
    s_waitcnt lgkmcnt(12)
    v_add_f32 v16, v16, v24
    v_add_f32 v17, v17, v25
    v_add_f32 v18, v18, v26
    v_add_f32 v19, v19, v27
    v_add_f32 v20, v20, v28
    v_add_f32 v21, v21, v29
    v_add_f32 v22, v22, v30
    v_add_f32 v23, v23, v31
    s_waitcnt lgkmcnt(10)
    v_add_f32 v16, v16, v32
    v_add_f32 v17, v17, v33
    v_add_f32 v18, v18, v34
    v_add_f32 v19, v19, v35
    v_add_f32 v20, v20, v36
    v_add_f32 v21, v21, v37
    v_add_f32 v22, v22, v38
    v_add_f32 v23, v23, v39
    s_waitcnt lgkmcnt(8)
    v_add_f32 v16, v16, v40
    v_add_f32 v17, v17, v41
    v_add_f32 v18, v18, v42
    v_add_f32 v19, v19, v43
    v_add_f32 v20, v20, v44
    v_add_f32 v21, v21, v45
    v_add_f32 v22, v22, v46
    v_add_f32 v23, v23, v47
    s_waitcnt lgkmcnt(6)
    v_add_f32 v16, v16, v48
    v_add_f32 v17, v17, v49
    v_add_f32 v18, v18, v50
    v_add_f32 v19, v19, v51
    v_add_f32 v20, v20, v52
    v_add_f32 v21, v21, v53
    v_add_f32 v22, v22, v54
    v_add_f32 v23, v23, v55
    s_waitcnt lgkmcnt(4)
    v_add_f32 v16, v16, v56
    v_add_f32 v17, v17, v57
    v_add_f32 v18, v18, v58
    v_add_f32 v19, v19, v59
    v_add_f32 v20, v20, v60
    v_add_f32 v21, v21, v61
    v_add_f32 v22, v22, v62
    v_add_f32 v23, v23, v63
    s_waitcnt lgkmcnt(2)
    v_add_f32 v16, v16, v64
    v_add_f32 v17, v17, v65
    v_add_f32 v18, v18, v66
    v_add_f32 v19, v19, v67
    v_add_f32 v20, v20, v68
    v_add_f32 v21, v21, v69
    v_add_f32 v22, v22, v70
    v_add_f32 v23, v23, v71
    s_waitcnt lgkmcnt(0)
    v_add_f32 v16, v16, v72
    v_add_f32 v17, v17, v73
    v_add_f32 v18, v18, v74
    v_add_f32 v19, v19, v75
    v_add_f32 v20, v20, v76
    v_add_f32 v21, v21, v77
    v_add_f32 v22, v22, v78
    v_add_f32 v23, v23, v79
    v_cvt_pk_bf16_f32 v80, v16, v17
    v_cvt_pk_bf16_f32 v81, v18, v19
    v_cvt_pk_bf16_f32 v82, v20, v21
    v_cvt_pk_bf16_f32 v83, v22, v23
    s_nop 0
    v_permlane32_swap_b32 v80, v82
    v_permlane32_swap_b32 v81, v83
    buffer_store_dwordx4 v[80:83], v11, s[12:15], s82 offen
    s_endpgm
K2_FFT:
    s_setprio 3
    s_lshl_b32 s73, s2, 13
    s_add_u32 s66, s73, 0x700000
    s_add_u32 s67, s66, 4096
    s_add_u32 s76, s73, 0x900000
    v_and_b32 v3, 31, v1
    v_lshrrev_b32 v4, 5, v1
    v_lshlrev_b32 v2, 6, v3
    v_lshl_add_u32 v2, v4, 4, v2
    v_lshlrev_b32 v5, 8, v3
    v_lshl_add_u32 v5, v4, 4, v5
    v_lshlrev_b32 v7, 4, v1
    v_add_u32 v6, s78, v7
    v_and_b32 v14, 31, v1
    v_lshlrev_b32 v14, 2, v14
    s_lshl_b32 s86, s74, 8
    s_add_u32 s86, s86, 0xb00000
    buffer_load_dword v8, v14, s[20:23], s86 offen
    buffer_load_dword v9, v14, s[20:23], s86 offen offset:128
    buffer_load_dwordx4 v[200:203], v2, s[20:23], s66 offen offset:0
    buffer_load_dwordx4 v[204:207], v2, s[20:23], s66 offen offset:32
    buffer_load_dwordx4 v[208:211], v2, s[20:23], s66 offen offset:2048
    buffer_load_dwordx4 v[212:215], v2, s[20:23], s66 offen offset:2080
    buffer_load_dwordx4 v[216:219], v2, s[20:23], s67 offen offset:0
    buffer_load_dwordx4 v[220:223], v2, s[20:23], s67 offen offset:32
    buffer_load_dwordx4 v[224:227], v2, s[20:23], s67 offen offset:2048
    buffer_load_dwordx4 v[228:231], v2, s[20:23], s67 offen offset:2080
    s_mov_b32 s79, 0xb80000
    buffer_load_dwordx4 v[16:19], v7, s[20:23], s79 offen offset:0
    buffer_load_dwordx4 v[20:23], v7, s[20:23], s79 offen offset:1024
    buffer_load_dwordx4 v[24:27], v7, s[20:23], s79 offen offset:2048
    buffer_load_dwordx4 v[28:31], v7, s[20:23], s79 offen offset:3072
    s_mov_b32 s79, 0xb81000
    buffer_load_dwordx4 v[32:35], v7, s[20:23], s79 offen offset:0
    buffer_load_dwordx4 v[36:39], v7, s[20:23], s79 offen offset:1024
    s_mov_b32 s79, 0xb81800
    buffer_load_dwordx4 v[40:43], v7, s[20:23], s79 offen offset:0
    buffer_load_dwordx4 v[44:47], v7, s[20:23], s79 offen offset:1024
    buffer_load_dwordx4 v[48:51], v7, s[20:23], s79 offen offset:2048
    buffer_load_dwordx4 v[52:55], v7, s[20:23], s79 offen offset:3072
    s_mov_b32 s79, 0xb82800
    buffer_load_dwordx4 v[56:59], v7, s[20:23], s79 offen offset:0
    buffer_load_dwordx4 v[60:63], v7, s[20:23], s79 offen offset:1024
    buffer_load_dwordx4 v[64:67], v7, s[20:23], s79 offen offset:2048
    buffer_load_dwordx4 v[68:71], v7, s[20:23], s79 offen offset:3072
    s_mov_b32 s79, 0xb83800
    buffer_load_dwordx4 v[72:75], v7, s[20:23], s79 offen offset:0
    buffer_load_dwordx4 v[76:79], v7, s[20:23], s79 offen offset:1024
    buffer_load_dwordx4 v[80:83], v7, s[20:23], s79 offen offset:2048
    buffer_load_dwordx4 v[84:87], v7, s[20:23], s79 offen offset:3072
    s_mov_b32 s79, 0xb84800
    buffer_load_dwordx4 v[88:91], v7, s[20:23], s79 offen offset:0
    buffer_load_dwordx4 v[92:95], v7, s[20:23], s79 offen offset:1024
    buffer_load_dwordx4 v[96:99], v7, s[20:23], s79 offen offset:2048
    buffer_load_dwordx4 v[100:103], v7, s[20:23], s79 offen offset:3072
    buffer_load_dwordx4 v[104:107], v5, s[20:23], s76 offen offset:0
    buffer_load_dwordx4 v[108:111], v5, s[20:23], s76 offen offset:32
    buffer_load_dwordx4 v[112:115], v5, s[20:23], s76 offen offset:64
    buffer_load_dwordx4 v[116:119], v5, s[20:23], s76 offen offset:96
    buffer_load_dwordx4 v[120:123], v5, s[20:23], s76 offen offset:128
    buffer_load_dwordx4 v[124:127], v5, s[20:23], s76 offen offset:160
    buffer_load_dwordx4 v[128:131], v5, s[20:23], s76 offen offset:192
    buffer_load_dwordx4 v[132:135], v5, s[20:23], s76 offen offset:224
    s_barrier
    v_cvt_f32_u32 v14, v3
    v_mul_f32 v14, 0x3a000000, v14
    v_lshlrev_b32 v15, 2, v4
    v_cvt_f32_u32 v15, v15
    v_add_f32 v5, 0x3c800000, v14
    v_mul_f32 v6, v15, v5
    v_mul_f32 v15, v15, v14
    s_waitcnt vmcnt(24)
    v_mfma_f32_32x32x16_bf16 v[136:151], v[200:203], v[16:19], 0
    v_mfma_f32_32x32x16_bf16 v[168:183], v[200:203], v[24:27], 0
    v_mfma_f32_32x32x16_bf16 v[136:151], v[204:207], v[20:23], v[136:151]
    v_mfma_f32_32x32x16_bf16 v[168:183], v[204:207], v[28:31], v[168:183]
    v_mfma_f32_32x32x16_bf16 v[136:151], v[216:219], v[32:35], v[136:151]
    v_mfma_f32_32x32x16_bf16 v[168:183], v[216:219], v[16:19], v[168:183]
    v_mfma_f32_32x32x16_bf16 v[136:151], v[220:223], v[36:39], v[136:151]
    v_mfma_f32_32x32x16_bf16 v[168:183], v[220:223], v[20:23], v[168:183]
    v_lshlrev_b32 v2, 6, v3
    v_lshl_add_u32 v2, v4, 5, v2
    s_lshl_b32 s77, s2, 12
    s_add_u32 s77, s77, 0xc00000
    v_mfma_f32_32x32x16_bf16 v[152:167], v[208:211], v[16:19], 0
    v_mfma_f32_32x32x16_bf16 v[184:199], v[208:211], v[24:27], 0
    v_fmamk_f32 v248, v14, 0x00000000, v15
    v_fmamk_f32 v249, v14, 0x3f800000, v15
    v_fmamk_f32 v250, v14, 0x40000000, v15
    v_fmamk_f32 v251, v14, 0x40400000, v15
    v_sin_f32 v252, v248
    v_sin_f32 v253, v249
    v_sin_f32 v254, v250
    v_sin_f32 v255, v251
    v_cos_f32 v248, v248
    v_cos_f32 v249, v249
    v_cos_f32 v250, v250
    v_cos_f32 v251, v251
    v_mul_f32 v7, v136, v252
    v_mul_f32 v252, v168, v252
    v_fma_f32 v136, v136, v248, v252
    v_fma_f32 v168, v168, v248, -v7
    v_mul_f32 v7, v137, v253
    v_mul_f32 v253, v169, v253
    v_fma_f32 v137, v137, v249, v253
    v_mfma_f32_32x32x16_bf16 v[152:167], v[212:215], v[20:23], v[152:167]
    v_fma_f32 v169, v169, v249, -v7
    v_mul_f32 v7, v138, v254
    v_mul_f32 v254, v170, v254
    v_fma_f32 v138, v138, v250, v254
    v_fma_f32 v170, v170, v250, -v7
    v_mul_f32 v7, v139, v255
    v_mul_f32 v255, v171, v255
    v_fma_f32 v139, v139, v251, v255
    v_fma_f32 v171, v171, v251, -v7
    v_fmamk_f32 v248, v14, 0x41000000, v15
    v_fmamk_f32 v249, v14, 0x41100000, v15
    v_fmamk_f32 v250, v14, 0x41200000, v15
    v_fmamk_f32 v251, v14, 0x41300000, v15
    v_sin_f32 v252, v248
    v_sin_f32 v253, v249
    v_sin_f32 v254, v250
    v_sin_f32 v255, v251
    v_cos_f32 v248, v248
    v_cos_f32 v249, v249
    v_mfma_f32_32x32x16_bf16 v[184:199], v[212:215], v[28:31], v[184:199]
    v_cos_f32 v250, v250
    v_cos_f32 v251, v251
    v_mul_f32 v7, v140, v252
    v_mul_f32 v252, v172, v252
    v_fma_f32 v140, v140, v248, v252
    v_fma_f32 v172, v172, v248, -v7
    v_mul_f32 v7, v141, v253
    v_mul_f32 v253, v173, v253
    v_fma_f32 v141, v141, v249, v253
    v_fma_f32 v173, v173, v249, -v7
    v_mul_f32 v7, v142, v254
    v_mul_f32 v254, v174, v254
    v_fma_f32 v142, v142, v250, v254
    v_fma_f32 v174, v174, v250, -v7
    v_mul_f32 v7, v143, v255
    v_mul_f32 v255, v175, v255
    v_fma_f32 v143, v143, v251, v255
    v_fma_f32 v175, v175, v251, -v7
    v_fmamk_f32 v248, v14, 0x41800000, v15
    v_fmamk_f32 v249, v14, 0x41880000, v15
    v_mfma_f32_32x32x16_bf16 v[152:167], v[224:227], v[32:35], v[152:167]
    v_fmamk_f32 v250, v14, 0x41900000, v15
    v_fmamk_f32 v251, v14, 0x41980000, v15
    v_sin_f32 v252, v248
    v_sin_f32 v253, v249
    v_sin_f32 v254, v250
    v_sin_f32 v255, v251
    v_cos_f32 v248, v248
    v_cos_f32 v249, v249
    v_cos_f32 v250, v250
    v_cos_f32 v251, v251
    v_mul_f32 v7, v144, v252
    v_mul_f32 v252, v176, v252
    v_fma_f32 v144, v144, v248, v252
    v_fma_f32 v176, v176, v248, -v7
    v_mul_f32 v7, v145, v253
    v_mul_f32 v253, v177, v253
    v_fma_f32 v145, v145, v249, v253
    v_fma_f32 v177, v177, v249, -v7
    v_mul_f32 v7, v146, v254
    v_mfma_f32_32x32x16_bf16 v[184:199], v[224:227], v[16:19], v[184:199]
    v_mul_f32 v254, v178, v254
    v_fma_f32 v146, v146, v250, v254
    v_fma_f32 v178, v178, v250, -v7
    v_mul_f32 v7, v147, v255
    v_mul_f32 v255, v179, v255
    v_fma_f32 v147, v147, v251, v255
    v_fma_f32 v179, v179, v251, -v7
    v_fmamk_f32 v248, v14, 0x41c00000, v15
    v_fmamk_f32 v249, v14, 0x41c80000, v15
    v_fmamk_f32 v250, v14, 0x41d00000, v15
    v_fmamk_f32 v251, v14, 0x41d80000, v15
    v_sin_f32 v252, v248
    v_sin_f32 v253, v249
    v_sin_f32 v254, v250
    v_sin_f32 v255, v251
    v_cos_f32 v248, v248
    v_cos_f32 v249, v249
    v_cos_f32 v250, v250
    v_cos_f32 v251, v251
    v_mul_f32 v7, v148, v252
    v_mfma_f32_32x32x16_bf16 v[152:167], v[228:231], v[36:39], v[152:167]
    v_mul_f32 v252, v180, v252
    v_fma_f32 v148, v148, v248, v252
    v_fma_f32 v180, v180, v248, -v7
    v_mul_f32 v7, v149, v253
    v_mul_f32 v253, v181, v253
    v_fma_f32 v149, v149, v249, v253
    v_fma_f32 v181, v181, v249, -v7
    v_mul_f32 v7, v150, v254
    v_mul_f32 v254, v182, v254
    v_fma_f32 v150, v150, v250, v254
    v_fma_f32 v182, v182, v250, -v7
    v_mul_f32 v7, v151, v255
    v_mul_f32 v255, v183, v255
    v_fma_f32 v151, v151, v251, v255
    v_fma_f32 v183, v183, v251, -v7
    v_cvt_pk_bf16_f32 v200, v136, v137
    v_cvt_pk_bf16_f32 v201, v138, v139
    v_cvt_pk_bf16_f32 v202, v140, v141
    v_cvt_pk_bf16_f32 v203, v142, v143
    v_mfma_f32_32x32x16_bf16 v[184:199], v[228:231], v[20:23], v[184:199]
    v_cvt_pk_bf16_f32 v204, v144, v145
    v_cvt_pk_bf16_f32 v205, v146, v147
    v_cvt_pk_bf16_f32 v206, v148, v149
    v_cvt_pk_bf16_f32 v207, v150, v151
    v_cvt_pk_bf16_f32 v216, v168, v169
    v_cvt_pk_bf16_f32 v217, v170, v171
    v_cvt_pk_bf16_f32 v218, v172, v173
    v_cvt_pk_bf16_f32 v219, v174, v175
    v_cvt_pk_bf16_f32 v220, v176, v177
    v_cvt_pk_bf16_f32 v221, v178, v179
    v_cvt_pk_bf16_f32 v222, v180, v181
    v_cvt_pk_bf16_f32 v223, v182, v183
    v_cvt_pk_bf16_f32 v232, -v168, -v169
    v_cvt_pk_bf16_f32 v233, -v170, -v171
    v_cvt_pk_bf16_f32 v234, -v172, -v173
    v_cvt_pk_bf16_f32 v235, -v174, -v175
    v_cvt_pk_bf16_f32 v236, -v176, -v177
    v_cvt_pk_bf16_f32 v237, -v178, -v179
    v_cvt_pk_bf16_f32 v238, -v180, -v181
    v_cvt_pk_bf16_f32 v239, -v182, -v183
    s_add_u32 s79, s77, 921600
    s_waitcnt vmcnt(8)
    v_mfma_f32_32x32x16_bf16 v[136:151], v[40:43], v[200:203], 0
    v_fmamk_f32 v248, v14, 0x42000000, v15
    v_fmamk_f32 v249, v14, 0x42040000, v15
    v_fmamk_f32 v250, v14, 0x42080000, v15
    v_fmamk_f32 v251, v14, 0x420c0000, v15
    v_sin_f32 v252, v248
    v_sin_f32 v253, v249
    v_sin_f32 v254, v250
    v_sin_f32 v255, v251
    v_cos_f32 v248, v248
    v_cos_f32 v249, v249
    v_cos_f32 v250, v250
    v_cos_f32 v251, v251
    v_mul_f32 v7, v152, v252
    v_mul_f32 v252, v184, v252
    v_fma_f32 v152, v152, v248, v252
    v_fma_f32 v184, v184, v248, -v7
    v_mul_f32 v7, v153, v253
    v_mfma_f32_32x32x16_bf16 v[168:183], v[72:75], v[200:203], 0
    v_mul_f32 v253, v185, v253
    v_fma_f32 v153, v153, v249, v253
    v_fma_f32 v185, v185, v249, -v7
    v_mul_f32 v7, v154, v254
    v_mul_f32 v254, v186, v254
    v_fma_f32 v154, v154, v250, v254
    v_fma_f32 v186, v186, v250, -v7
    v_mul_f32 v7, v155, v255
    v_mul_f32 v255, v187, v255
    v_fma_f32 v155, v155, v251, v255
    v_fma_f32 v187, v187, v251, -v7
    v_fmamk_f32 v248, v14, 0x42200000, v15
    v_fmamk_f32 v249, v14, 0x42240000, v15
    v_fmamk_f32 v250, v14, 0x42280000, v15
    v_fmamk_f32 v251, v14, 0x422c0000, v15
    v_sin_f32 v252, v248
    v_sin_f32 v253, v249
    v_mfma_f32_32x32x16_bf16 v[136:151], v[72:75], v[232:235], v[136:151]
    v_sin_f32 v254, v250
    v_sin_f32 v255, v251
    v_cos_f32 v248, v248
    v_cos_f32 v249, v249
    v_cos_f32 v250, v250
    v_cos_f32 v251, v251
    v_mul_f32 v7, v156, v252
    v_mul_f32 v252, v188, v252
    v_fma_f32 v156, v156, v248, v252
    v_fma_f32 v188, v188, v248, -v7
    v_mul_f32 v7, v157, v253
    v_mul_f32 v253, v189, v253
    v_fma_f32 v157, v157, v249, v253
    v_fma_f32 v189, v189, v249, -v7
    v_mul_f32 v7, v158, v254
    v_mul_f32 v254, v190, v254
    v_fma_f32 v158, v158, v250, v254
    v_mfma_f32_32x32x16_bf16 v[168:183], v[40:43], v[216:219], v[168:183]
    v_fma_f32 v190, v190, v250, -v7
    v_mul_f32 v7, v159, v255
    v_mul_f32 v255, v191, v255
    v_fma_f32 v159, v159, v251, v255
    v_fma_f32 v191, v191, v251, -v7
    v_fmamk_f32 v248, v14, 0x42400000, v15
    v_fmamk_f32 v249, v14, 0x42440000, v15
    v_fmamk_f32 v250, v14, 0x42480000, v15
    v_fmamk_f32 v251, v14, 0x424c0000, v15
    v_sin_f32 v252, v248
    v_sin_f32 v253, v249
    v_sin_f32 v254, v250
    v_sin_f32 v255, v251
    v_cos_f32 v248, v248
    v_cos_f32 v249, v249
    v_cos_f32 v250, v250
    v_cos_f32 v251, v251
    v_mfma_f32_32x32x16_bf16 v[136:151], v[44:47], v[204:207], v[136:151]
    v_mul_f32 v7, v160, v252
    v_mul_f32 v252, v192, v252
    v_fma_f32 v160, v160, v248, v252
    v_fma_f32 v192, v192, v248, -v7
    v_mul_f32 v7, v161, v253
    v_mul_f32 v253, v193, v253
    v_fma_f32 v161, v161, v249, v253
    v_fma_f32 v193, v193, v249, -v7
    v_mul_f32 v7, v162, v254
    v_mul_f32 v254, v194, v254
    v_fma_f32 v162, v162, v250, v254
    v_fma_f32 v194, v194, v250, -v7
    v_mul_f32 v7, v163, v255
    v_mul_f32 v255, v195, v255
    v_fma_f32 v163, v163, v251, v255
    v_fma_f32 v195, v195, v251, -v7
    v_fmamk_f32 v248, v14, 0x42600000, v15
    v_mfma_f32_32x32x16_bf16 v[168:183], v[76:79], v[204:207], v[168:183]
    v_fmamk_f32 v249, v14, 0x42640000, v15
    v_fmamk_f32 v250, v14, 0x42680000, v15
    v_fmamk_f32 v251, v14, 0x426c0000, v15
    v_sin_f32 v252, v248
    v_sin_f32 v253, v249
    v_sin_f32 v254, v250
    v_sin_f32 v255, v251
    v_cos_f32 v248, v248
    v_cos_f32 v249, v249
    v_cos_f32 v250, v250
    v_cos_f32 v251, v251
    v_mul_f32 v7, v164, v252
    v_mul_f32 v252, v196, v252
    v_fma_f32 v164, v164, v248, v252
    v_fma_f32 v196, v196, v248, -v7
    v_mul_f32 v7, v165, v253
    v_mul_f32 v253, v197, v253
    v_mfma_f32_32x32x16_bf16 v[136:151], v[76:79], v[236:239], v[136:151]
    v_fma_f32 v165, v165, v249, v253
    v_fma_f32 v197, v197, v249, -v7
    v_mul_f32 v7, v166, v254
    v_mul_f32 v254, v198, v254
    v_fma_f32 v166, v166, v250, v254
    v_fma_f32 v198, v198, v250, -v7
    v_mul_f32 v7, v167, v255
    v_mul_f32 v255, v199, v255
    v_fma_f32 v167, v167, v251, v255
    v_fma_f32 v199, v199, v251, -v7
    v_cvt_pk_bf16_f32 v208, v152, v153
    v_cvt_pk_bf16_f32 v209, v154, v155
    v_cvt_pk_bf16_f32 v210, v156, v157
    v_cvt_pk_bf16_f32 v211, v158, v159
    v_cvt_pk_bf16_f32 v212, v160, v161
    v_cvt_pk_bf16_f32 v213, v162, v163
    v_cvt_pk_bf16_f32 v214, v164, v165
    v_mfma_f32_32x32x16_bf16 v[168:183], v[44:47], v[220:223], v[168:183]
    v_cvt_pk_bf16_f32 v215, v166, v167
    v_cvt_pk_bf16_f32 v224, v184, v185
    v_cvt_pk_bf16_f32 v225, v186, v187
    v_cvt_pk_bf16_f32 v226, v188, v189
    v_cvt_pk_bf16_f32 v227, v190, v191
    v_cvt_pk_bf16_f32 v228, v192, v193
    v_cvt_pk_bf16_f32 v229, v194, v195
    v_cvt_pk_bf16_f32 v230, v196, v197
    v_cvt_pk_bf16_f32 v231, v198, v199
    v_cvt_pk_bf16_f32 v240, -v184, -v185
    v_cvt_pk_bf16_f32 v241, -v186, -v187
    v_cvt_pk_bf16_f32 v242, -v188, -v189
    v_cvt_pk_bf16_f32 v243, -v190, -v191
    v_cvt_pk_bf16_f32 v244, -v192, -v193
    v_cvt_pk_bf16_f32 v245, -v194, -v195
    v_cvt_pk_bf16_f32 v246, -v196, -v197
    v_cvt_pk_bf16_f32 v247, -v198, -v199
    v_mfma_f32_32x32x16_bf16 v[136:151], v[48:51], v[208:211], v[136:151]
    v_mfma_f32_32x32x16_bf16 v[168:183], v[80:83], v[208:211], v[168:183]
    v_mfma_f32_32x32x16_bf16 v[136:151], v[80:83], v[240:243], v[136:151]
    v_mfma_f32_32x32x16_bf16 v[168:183], v[48:51], v[224:227], v[168:183]
    v_mfma_f32_32x32x16_bf16 v[136:151], v[52:55], v[212:215], v[136:151]
    v_mfma_f32_32x32x16_bf16 v[168:183], v[84:87], v[212:215], v[168:183]
    v_mfma_f32_32x32x16_bf16 v[136:151], v[84:87], v[244:247], v[136:151]
    v_mfma_f32_32x32x16_bf16 v[168:183], v[52:55], v[228:231], v[168:183]
    s_waitcnt vmcnt(0)
    v_mfma_f32_32x32x16_bf16 v[152:167], v[56:59], v[200:203], 0
    v_mfma_f32_32x32x16_bf16 v[184:199], v[88:91], v[200:203], 0
    v_lshlrev_b32 v10, 16, v104
    v_and_b32 v11, 0xffff0000, v104
    s_nop 5
    v_mul_f32 v12, v136, v11
    v_mul_f32 v13, v168, v11
    v_fma_f32 v136, v136, v10, -v13
    v_fma_f32 v168, v168, v10, v12
    v_mfma_f32_32x32x16_bf16 v[152:167], v[88:91], v[232:235], v[152:167]
    v_lshlrev_b32 v10, 16, v105
    v_and_b32 v11, 0xffff0000, v105
    v_mul_f32 v12, v137, v11
    v_mul_f32 v13, v169, v11
    v_fma_f32 v137, v137, v10, -v13
    v_fma_f32 v169, v169, v10, v12
    v_mfma_f32_32x32x16_bf16 v[184:199], v[56:59], v[216:219], v[184:199]
    v_lshlrev_b32 v10, 16, v106
    v_and_b32 v11, 0xffff0000, v106
    v_mul_f32 v12, v138, v11
    v_mul_f32 v13, v170, v11
    v_fma_f32 v138, v138, v10, -v13
    v_fma_f32 v170, v170, v10, v12
    v_lshlrev_b32 v10, 16, v107
    v_mfma_f32_32x32x16_bf16 v[152:167], v[60:63], v[204:207], v[152:167]
    v_and_b32 v11, 0xffff0000, v107
    v_mul_f32 v12, v139, v11
    v_mul_f32 v13, v171, v11
    v_fma_f32 v139, v139, v10, -v13
    v_fma_f32 v171, v171, v10, v12
    v_lshlrev_b32 v10, 16, v108
    v_mfma_f32_32x32x16_bf16 v[184:199], v[92:95], v[204:207], v[184:199]
    v_and_b32 v11, 0xffff0000, v108
    v_mul_f32 v12, v140, v11
    v_mul_f32 v13, v172, v11
    v_fma_f32 v140, v140, v10, -v13
    v_fma_f32 v172, v172, v10, v12
    v_lshlrev_b32 v10, 16, v109
    v_and_b32 v11, 0xffff0000, v109
    v_mfma_f32_32x32x16_bf16 v[152:167], v[92:95], v[236:239], v[152:167]
    v_mul_f32 v12, v141, v11
    v_mul_f32 v13, v173, v11
    v_fma_f32 v141, v141, v10, -v13
    v_fma_f32 v173, v173, v10, v12
    v_lshlrev_b32 v10, 16, v110
    v_and_b32 v11, 0xffff0000, v110
    v_mfma_f32_32x32x16_bf16 v[184:199], v[60:63], v[220:223], v[184:199]
    v_mul_f32 v12, v142, v11
    v_mul_f32 v13, v174, v11
    v_fma_f32 v142, v142, v10, -v13
    v_fma_f32 v174, v174, v10, v12
    v_lshlrev_b32 v10, 16, v111
    v_and_b32 v11, 0xffff0000, v111
    v_mfma_f32_32x32x16_bf16 v[152:167], v[64:67], v[208:211], v[152:167]
    v_mul_f32 v12, v143, v11
    v_mul_f32 v13, v175, v11
    v_fma_f32 v143, v143, v10, -v13
    v_fma_f32 v175, v175, v10, v12
    v_lshlrev_b32 v10, 16, v112
    v_and_b32 v11, 0xffff0000, v112
    v_mul_f32 v12, v144, v11
    v_mfma_f32_32x32x16_bf16 v[184:199], v[96:99], v[208:211], v[184:199]
    v_mul_f32 v13, v176, v11
    v_fma_f32 v144, v144, v10, -v13
    v_fma_f32 v176, v176, v10, v12
    v_lshlrev_b32 v10, 16, v113
    v_and_b32 v11, 0xffff0000, v113
    v_mul_f32 v12, v145, v11
    v_mfma_f32_32x32x16_bf16 v[152:167], v[96:99], v[240:243], v[152:167]
    v_mul_f32 v13, v177, v11
    v_fma_f32 v145, v145, v10, -v13
    v_fma_f32 v177, v177, v10, v12
    v_lshlrev_b32 v10, 16, v114
    v_and_b32 v11, 0xffff0000, v114
    v_mul_f32 v12, v146, v11
    v_mul_f32 v13, v178, v11
    v_mfma_f32_32x32x16_bf16 v[184:199], v[64:67], v[224:227], v[184:199]
    v_fma_f32 v146, v146, v10, -v13
    v_fma_f32 v178, v178, v10, v12
    v_lshlrev_b32 v10, 16, v115
    v_and_b32 v11, 0xffff0000, v115
    v_mul_f32 v12, v147, v11
    v_mul_f32 v13, v179, v11
    v_mfma_f32_32x32x16_bf16 v[152:167], v[68:71], v[212:215], v[152:167]
    v_fma_f32 v147, v147, v10, -v13
    v_fma_f32 v179, v179, v10, v12
    v_lshlrev_b32 v10, 16, v116
    v_and_b32 v11, 0xffff0000, v116
    v_mul_f32 v12, v148, v11
    v_mul_f32 v13, v180, v11
    v_mfma_f32_32x32x16_bf16 v[184:199], v[100:103], v[212:215], v[184:199]
    v_fma_f32 v148, v148, v10, -v13
    v_fma_f32 v180, v180, v10, v12
    v_lshlrev_b32 v10, 16, v117
    v_and_b32 v11, 0xffff0000, v117
    v_mul_f32 v12, v149, v11
    v_mul_f32 v13, v181, v11
    v_fma_f32 v149, v149, v10, -v13
    v_mfma_f32_32x32x16_bf16 v[152:167], v[100:103], v[244:247], v[152:167]
    v_fma_f32 v181, v181, v10, v12
    v_lshlrev_b32 v10, 16, v118
    v_and_b32 v11, 0xffff0000, v118
    v_mul_f32 v12, v150, v11
    v_mul_f32 v13, v182, v11
    v_fma_f32 v150, v150, v10, -v13
    v_mfma_f32_32x32x16_bf16 v[184:199], v[68:71], v[228:231], v[184:199]
    v_fma_f32 v182, v182, v10, v12
    v_lshlrev_b32 v10, 16, v119
    v_and_b32 v11, 0xffff0000, v119
    v_mul_f32 v12, v151, v11
    v_mul_f32 v13, v183, v11
    v_fma_f32 v151, v151, v10, -v13
    v_fma_f32 v183, v183, v10, v12
    v_cvt_pk_bf16_f32 v200, v136, v137
    v_cvt_pk_bf16_f32 v201, v138, v139
    v_cvt_pk_bf16_f32 v202, v140, v141
    v_cvt_pk_bf16_f32 v203, v142, v143
    v_cvt_pk_bf16_f32 v204, v144, v145
    v_cvt_pk_bf16_f32 v205, v146, v147
    v_cvt_pk_bf16_f32 v206, v148, v149
    v_cvt_pk_bf16_f32 v207, v150, v151
    v_cvt_pk_bf16_f32 v216, v168, v169
    v_cvt_pk_bf16_f32 v217, v170, v171
    v_cvt_pk_bf16_f32 v218, v172, v173
    v_cvt_pk_bf16_f32 v219, v174, v175
    v_cvt_pk_bf16_f32 v220, v176, v177
    v_cvt_pk_bf16_f32 v221, v178, v179
    v_cvt_pk_bf16_f32 v222, v180, v181
    v_cvt_pk_bf16_f32 v223, v182, v183
    v_cvt_pk_bf16_f32 v232, -v136, -v137
    v_cvt_pk_bf16_f32 v233, -v138, -v139
    v_cvt_pk_bf16_f32 v234, -v140, -v141
    v_cvt_pk_bf16_f32 v235, -v142, -v143
    v_cvt_pk_bf16_f32 v236, -v144, -v145
    v_cvt_pk_bf16_f32 v237, -v146, -v147
    v_cvt_pk_bf16_f32 v238, -v148, -v149
    v_cvt_pk_bf16_f32 v239, -v150, -v151
    v_mfma_f32_32x32x16_bf16 v[136:151], v[200:203], v[40:43], 0
    v_lshlrev_b32 v10, 16, v120
    v_and_b32 v11, 0xffff0000, v120
    v_mul_f32 v12, v152, v11
    v_mul_f32 v13, v184, v11
    v_fma_f32 v152, v152, v10, -v13
    v_fma_f32 v184, v184, v10, v12
    v_lshlrev_b32 v10, 16, v121
    v_and_b32 v11, 0xffff0000, v121
    v_mul_f32 v12, v153, v11
    v_mul_f32 v13, v185, v11
    v_fma_f32 v153, v153, v10, -v13
    v_fma_f32 v185, v185, v10, v12
    v_lshlrev_b32 v10, 16, v122
    v_and_b32 v11, 0xffff0000, v122
    v_mul_f32 v12, v154, v11
    v_mfma_f32_32x32x16_bf16 v[168:183], v[216:219], v[40:43], 0
    v_mul_f32 v13, v186, v11
    v_fma_f32 v154, v154, v10, -v13
    v_fma_f32 v186, v186, v10, v12
    v_lshlrev_b32 v10, 16, v123
    v_and_b32 v11, 0xffff0000, v123
    v_mul_f32 v12, v155, v11
    v_mul_f32 v13, v187, v11
    v_fma_f32 v155, v155, v10, -v13
    v_fma_f32 v187, v187, v10, v12
    v_lshlrev_b32 v10, 16, v124
    v_and_b32 v11, 0xffff0000, v124
    v_mul_f32 v12, v156, v11
    v_mul_f32 v13, v188, v11
    v_fma_f32 v156, v156, v10, -v13
    v_fma_f32 v188, v188, v10, v12
    v_mfma_f32_32x32x16_bf16 v[136:151], v[216:219], v[72:75], v[136:151]
    v_lshlrev_b32 v10, 16, v125
    v_and_b32 v11, 0xffff0000, v125
    v_mul_f32 v12, v157, v11
    v_mul_f32 v13, v189, v11
    v_fma_f32 v157, v157, v10, -v13
    v_fma_f32 v189, v189, v10, v12
    v_lshlrev_b32 v10, 16, v126
    v_and_b32 v11, 0xffff0000, v126
    v_mul_f32 v12, v158, v11
    v_mul_f32 v13, v190, v11
    v_fma_f32 v158, v158, v10, -v13
    v_fma_f32 v190, v190, v10, v12
    v_lshlrev_b32 v10, 16, v127
    v_and_b32 v11, 0xffff0000, v127
    v_mul_f32 v12, v159, v11
    v_mfma_f32_32x32x16_bf16 v[168:183], v[232:235], v[72:75], v[168:183]
    v_mul_f32 v13, v191, v11
    v_fma_f32 v159, v159, v10, -v13
    v_fma_f32 v191, v191, v10, v12
    v_lshlrev_b32 v10, 16, v128
    v_and_b32 v11, 0xffff0000, v128
    v_mul_f32 v12, v160, v11
    v_mul_f32 v13, v192, v11
    v_fma_f32 v160, v160, v10, -v13
    v_fma_f32 v192, v192, v10, v12
    v_lshlrev_b32 v10, 16, v129
    v_and_b32 v11, 0xffff0000, v129
    v_mul_f32 v12, v161, v11
    v_mul_f32 v13, v193, v11
    v_fma_f32 v161, v161, v10, -v13
    v_fma_f32 v193, v193, v10, v12
    v_mfma_f32_32x32x16_bf16 v[136:151], v[204:207], v[44:47], v[136:151]
    v_lshlrev_b32 v10, 16, v130
    v_and_b32 v11, 0xffff0000, v130
    v_mul_f32 v12, v162, v11
    v_mul_f32 v13, v194, v11
    v_fma_f32 v162, v162, v10, -v13
    v_fma_f32 v194, v194, v10, v12
    v_lshlrev_b32 v10, 16, v131
    v_and_b32 v11, 0xffff0000, v131
    v_mul_f32 v12, v163, v11
    v_mul_f32 v13, v195, v11
    v_fma_f32 v163, v163, v10, -v13
    v_fma_f32 v195, v195, v10, v12
    v_lshlrev_b32 v10, 16, v132
    v_and_b32 v11, 0xffff0000, v132
    v_mul_f32 v12, v164, v11
    v_mfma_f32_32x32x16_bf16 v[168:183], v[220:223], v[44:47], v[168:183]
    v_mul_f32 v13, v196, v11
    v_fma_f32 v164, v164, v10, -v13
    v_fma_f32 v196, v196, v10, v12
    v_lshlrev_b32 v10, 16, v133
    v_and_b32 v11, 0xffff0000, v133
    v_mul_f32 v12, v165, v11
    v_mul_f32 v13, v197, v11
    v_fma_f32 v165, v165, v10, -v13
    v_fma_f32 v197, v197, v10, v12
    v_lshlrev_b32 v10, 16, v134
    v_and_b32 v11, 0xffff0000, v134
    v_mul_f32 v12, v166, v11
    v_mul_f32 v13, v198, v11
    v_fma_f32 v166, v166, v10, -v13
    v_fma_f32 v198, v198, v10, v12
    v_mfma_f32_32x32x16_bf16 v[136:151], v[220:223], v[76:79], v[136:151]
    v_lshlrev_b32 v10, 16, v135
    v_and_b32 v11, 0xffff0000, v135
    v_mul_f32 v12, v167, v11
    v_mul_f32 v13, v199, v11
    v_fma_f32 v167, v167, v10, -v13
    v_fma_f32 v199, v199, v10, v12
    v_cvt_pk_bf16_f32 v208, v152, v153
    v_cvt_pk_bf16_f32 v209, v154, v155
    v_cvt_pk_bf16_f32 v210, v156, v157
    v_cvt_pk_bf16_f32 v211, v158, v159
    v_cvt_pk_bf16_f32 v212, v160, v161
    v_cvt_pk_bf16_f32 v213, v162, v163
    v_cvt_pk_bf16_f32 v214, v164, v165
    v_cvt_pk_bf16_f32 v215, v166, v167
    v_cvt_pk_bf16_f32 v224, v184, v185
    v_mfma_f32_32x32x16_bf16 v[168:183], v[236:239], v[76:79], v[168:183]
    v_cvt_pk_bf16_f32 v225, v186, v187
    v_cvt_pk_bf16_f32 v226, v188, v189
    v_cvt_pk_bf16_f32 v227, v190, v191
    v_cvt_pk_bf16_f32 v228, v192, v193
    v_cvt_pk_bf16_f32 v229, v194, v195
    v_cvt_pk_bf16_f32 v230, v196, v197
    v_cvt_pk_bf16_f32 v231, v198, v199
    v_cvt_pk_bf16_f32 v240, -v152, -v153
    v_cvt_pk_bf16_f32 v241, -v154, -v155
    v_cvt_pk_bf16_f32 v242, -v156, -v157
    v_cvt_pk_bf16_f32 v243, -v158, -v159
    v_cvt_pk_bf16_f32 v244, -v160, -v161
    v_cvt_pk_bf16_f32 v245, -v162, -v163
    v_cvt_pk_bf16_f32 v246, -v164, -v165
    v_cvt_pk_bf16_f32 v247, -v166, -v167
    v_mfma_f32_32x32x16_bf16 v[136:151], v[208:211], v[48:51], v[136:151]
    v_mfma_f32_32x32x16_bf16 v[168:183], v[224:227], v[48:51], v[168:183]
    v_mfma_f32_32x32x16_bf16 v[136:151], v[224:227], v[80:83], v[136:151]
    v_mfma_f32_32x32x16_bf16 v[168:183], v[240:243], v[80:83], v[168:183]
    v_mfma_f32_32x32x16_bf16 v[136:151], v[212:215], v[52:55], v[136:151]
    v_mfma_f32_32x32x16_bf16 v[168:183], v[228:231], v[52:55], v[168:183]
    v_mfma_f32_32x32x16_bf16 v[136:151], v[228:231], v[84:87], v[136:151]
    v_mfma_f32_32x32x16_bf16 v[168:183], v[244:247], v[84:87], v[168:183]
    v_mfma_f32_32x32x16_bf16 v[152:167], v[200:203], v[56:59], 0
    v_mfma_f32_32x32x16_bf16 v[184:199], v[216:219], v[56:59], 0
    v_fmamk_f32 v248, v14, 0x00000000, v15
    v_fmamk_f32 v249, v14, 0x3f800000, v15
    v_fmamk_f32 v250, v14, 0x40000000, v15
    v_fmamk_f32 v251, v14, 0x40400000, v15
    v_sin_f32 v252, v248
    v_sin_f32 v253, v249
    v_sin_f32 v254, v250
    v_mfma_f32_32x32x16_bf16 v[152:167], v[216:219], v[88:91], v[152:167]
    v_sin_f32 v255, v251
    v_cos_f32 v248, v248
    v_cos_f32 v249, v249
    v_cos_f32 v250, v250
    v_cos_f32 v251, v251
    v_mul_f32 v7, v136, v252
    v_mul_f32 v252, v168, v252
    v_mfma_f32_32x32x16_bf16 v[184:199], v[232:235], v[88:91], v[184:199]
    v_fma_f32 v136, v136, v248, -v252
    v_fma_f32 v168, v168, v248, v7
    v_mul_f32 v7, v137, v253
    v_mul_f32 v253, v169, v253
    v_fma_f32 v137, v137, v249, -v253
    v_fma_f32 v169, v169, v249, v7
    v_mul_f32 v7, v138, v254
    v_mul_f32 v254, v170, v254
    v_mfma_f32_32x32x16_bf16 v[152:167], v[204:207], v[60:63], v[152:167]
    v_fma_f32 v138, v138, v250, -v254
    v_fma_f32 v170, v170, v250, v7
    v_mul_f32 v7, v139, v255
    v_mul_f32 v255, v171, v255
    v_fma_f32 v139, v139, v251, -v255
    v_fma_f32 v171, v171, v251, v7
    v_fmamk_f32 v248, v14, 0x41000000, v15
    v_mfma_f32_32x32x16_bf16 v[184:199], v[220:223], v[60:63], v[184:199]
    v_fmamk_f32 v249, v14, 0x41100000, v15
    v_fmamk_f32 v250, v14, 0x41200000, v15
    v_fmamk_f32 v251, v14, 0x41300000, v15
    v_sin_f32 v252, v248
    v_sin_f32 v253, v249
    v_sin_f32 v254, v250
    v_sin_f32 v255, v251
    v_cos_f32 v248, v248
    v_mfma_f32_32x32x16_bf16 v[152:167], v[220:223], v[92:95], v[152:167]
    v_cos_f32 v249, v249
    v_cos_f32 v250, v250
    v_cos_f32 v251, v251
    v_mul_f32 v7, v140, v252
    v_mul_f32 v252, v172, v252
    v_fma_f32 v140, v140, v248, -v252
    v_fma_f32 v172, v172, v248, v7
    v_mfma_f32_32x32x16_bf16 v[184:199], v[236:239], v[92:95], v[184:199]
    v_mul_f32 v7, v141, v253
    v_mul_f32 v253, v173, v253
    v_fma_f32 v141, v141, v249, -v253
    v_fma_f32 v173, v173, v249, v7
    v_mul_f32 v7, v142, v254
    v_mul_f32 v254, v174, v254
    v_fma_f32 v142, v142, v250, -v254
    v_fma_f32 v174, v174, v250, v7
    v_mfma_f32_32x32x16_bf16 v[152:167], v[208:211], v[64:67], v[152:167]
    v_mul_f32 v7, v143, v255
    v_mul_f32 v255, v175, v255
    v_fma_f32 v143, v143, v251, -v255
    v_fma_f32 v175, v175, v251, v7
    v_fmamk_f32 v248, v14, 0x41800000, v15
    v_fmamk_f32 v249, v14, 0x41880000, v15
    v_fmamk_f32 v250, v14, 0x41900000, v15
    v_mfma_f32_32x32x16_bf16 v[184:199], v[224:227], v[64:67], v[184:199]
    v_fmamk_f32 v251, v14, 0x41980000, v15
    v_sin_f32 v252, v248
    v_sin_f32 v253, v249
    v_sin_f32 v254, v250
    v_sin_f32 v255, v251
    v_cos_f32 v248, v248
    v_cos_f32 v249, v249
    v_cos_f32 v250, v250
    v_mfma_f32_32x32x16_bf16 v[152:167], v[224:227], v[96:99], v[152:167]
    v_cos_f32 v251, v251
    v_mul_f32 v7, v144, v252
    v_mul_f32 v252, v176, v252
    v_fma_f32 v144, v144, v248, -v252
    v_fma_f32 v176, v176, v248, v7
    v_mul_f32 v7, v145, v253
    v_mul_f32 v253, v177, v253
    v_mfma_f32_32x32x16_bf16 v[184:199], v[240:243], v[96:99], v[184:199]
    v_fma_f32 v145, v145, v249, -v253
    v_fma_f32 v177, v177, v249, v7
    v_mul_f32 v7, v146, v254
    v_mul_f32 v254, v178, v254
    v_fma_f32 v146, v146, v250, -v254
    v_fma_f32 v178, v178, v250, v7
    v_mul_f32 v7, v147, v255
    v_mul_f32 v255, v179, v255
    v_mfma_f32_32x32x16_bf16 v[152:167], v[212:215], v[68:71], v[152:167]
    v_fma_f32 v147, v147, v251, -v255
    v_fma_f32 v179, v179, v251, v7
    v_fmamk_f32 v248, v14, 0x41c00000, v15
    v_fmamk_f32 v249, v14, 0x41c80000, v15
    v_fmamk_f32 v250, v14, 0x41d00000, v15
    v_fmamk_f32 v251, v14, 0x41d80000, v15
    v_sin_f32 v252, v248
    v_mfma_f32_32x32x16_bf16 v[184:199], v[228:231], v[68:71], v[184:199]
    v_sin_f32 v253, v249
    v_sin_f32 v254, v250
    v_sin_f32 v255, v251
    v_cos_f32 v248, v248
    v_cos_f32 v249, v249
    v_cos_f32 v250, v250
    v_cos_f32 v251, v251
    v_mul_f32 v7, v148, v252
    v_mfma_f32_32x32x16_bf16 v[152:167], v[228:231], v[100:103], v[152:167]
    v_mul_f32 v252, v180, v252
    v_fma_f32 v148, v148, v248, -v252
    v_fma_f32 v180, v180, v248, v7
    v_mul_f32 v7, v149, v253
    v_mul_f32 v253, v181, v253
    v_fma_f32 v149, v149, v249, -v253
    v_fma_f32 v181, v181, v249, v7
    v_mfma_f32_32x32x16_bf16 v[184:199], v[244:247], v[100:103], v[184:199]
    v_mul_f32 v7, v150, v254
    v_mul_f32 v254, v182, v254
    v_fma_f32 v150, v150, v250, -v254
    v_fma_f32 v182, v182, v250, v7
    v_mul_f32 v7, v151, v255
    v_mul_f32 v255, v183, v255
    v_fma_f32 v151, v151, v251, -v255
    v_fma_f32 v183, v183, v251, v7
    v_cvt_pk_bf16_f32 v200, v136, v137
    v_cvt_pk_bf16_f32 v201, v138, v139
    v_cvt_pk_bf16_f32 v202, v140, v141
    v_cvt_pk_bf16_f32 v203, v142, v143
    v_cvt_pk_bf16_f32 v204, v144, v145
    v_cvt_pk_bf16_f32 v205, v146, v147
    v_cvt_pk_bf16_f32 v206, v148, v149
    v_cvt_pk_bf16_f32 v207, v150, v151
    v_cvt_pk_bf16_f32 v216, v168, v169
    v_cvt_pk_bf16_f32 v217, v170, v171
    v_cvt_pk_bf16_f32 v218, v172, v173
    v_cvt_pk_bf16_f32 v219, v174, v175
    v_cvt_pk_bf16_f32 v220, v176, v177
    v_cvt_pk_bf16_f32 v221, v178, v179
    v_cvt_pk_bf16_f32 v222, v180, v181
    v_cvt_pk_bf16_f32 v223, v182, v183
    v_mfma_f32_32x32x16_bf16 v[136:151], v[16:19], v[200:203], 0
    v_fmamk_f32 v248, v5, 0x00000000, v6
    v_fmamk_f32 v249, v5, 0x3f800000, v6
    v_fmamk_f32 v250, v5, 0x40000000, v6
    v_fmamk_f32 v251, v5, 0x40400000, v6
    v_sin_f32 v252, v248
    v_sin_f32 v253, v249
    v_sin_f32 v254, v250
    v_sin_f32 v255, v251
    v_cos_f32 v248, v248
    v_cos_f32 v249, v249
    v_cos_f32 v250, v250
    v_cos_f32 v251, v251
    v_mul_f32 v7, v152, v252
    v_mul_f32 v252, v184, v252
    v_fma_f32 v152, v152, v248, -v252
    v_fma_f32 v184, v184, v248, v7
    v_mfma_f32_32x32x16_bf16 v[168:183], v[16:19], v[216:219], 0
    v_mul_f32 v7, v153, v253
    v_mul_f32 v253, v185, v253
    v_fma_f32 v153, v153, v249, -v253
    v_fma_f32 v185, v185, v249, v7
    v_mul_f32 v7, v154, v254
    v_mul_f32 v254, v186, v254
    v_fma_f32 v154, v154, v250, -v254
    v_fma_f32 v186, v186, v250, v7
    v_mul_f32 v7, v155, v255
    v_mul_f32 v255, v187, v255
    v_fma_f32 v155, v155, v251, -v255
    v_fma_f32 v187, v187, v251, v7
    v_fmamk_f32 v248, v5, 0x41000000, v6
    v_fmamk_f32 v249, v5, 0x41100000, v6
    v_fmamk_f32 v250, v5, 0x41200000, v6
    v_fmamk_f32 v251, v5, 0x41300000, v6
    v_mfma_f32_32x32x16_bf16 v[136:151], v[20:23], v[204:207], v[136:151]
    v_sin_f32 v252, v248
    v_sin_f32 v253, v249
    v_sin_f32 v254, v250
    v_sin_f32 v255, v251
    v_cos_f32 v248, v248
    v_cos_f32 v249, v249
    v_cos_f32 v250, v250
    v_cos_f32 v251, v251
    v_mul_f32 v7, v156, v252
    v_mul_f32 v252, v188, v252
    v_fma_f32 v156, v156, v248, -v252
    v_fma_f32 v188, v188, v248, v7
    v_mul_f32 v7, v157, v253
    v_mul_f32 v253, v189, v253
    v_fma_f32 v157, v157, v249, -v253
    v_fma_f32 v189, v189, v249, v7
    v_mfma_f32_32x32x16_bf16 v[168:183], v[20:23], v[220:223], v[168:183]
    v_mul_f32 v7, v158, v254
    v_mul_f32 v254, v190, v254
    v_fma_f32 v158, v158, v250, -v254
    v_fma_f32 v190, v190, v250, v7
    v_mul_f32 v7, v159, v255
    v_mul_f32 v255, v191, v255
    v_fma_f32 v159, v159, v251, -v255
    v_fma_f32 v191, v191, v251, v7
    v_fmamk_f32 v248, v5, 0x41800000, v6
    v_fmamk_f32 v249, v5, 0x41880000, v6
    v_fmamk_f32 v250, v5, 0x41900000, v6
    v_fmamk_f32 v251, v5, 0x41980000, v6
    v_sin_f32 v252, v248
    v_sin_f32 v253, v249
    v_sin_f32 v254, v250
    v_sin_f32 v255, v251
    v_mfma_f32_32x32x16_bf16 v[136:151], v[24:27], v[216:219], v[136:151]
    v_cos_f32 v248, v248
    v_cos_f32 v249, v249
    v_cos_f32 v250, v250
    v_cos_f32 v251, v251
    v_mul_f32 v7, v160, v252
    v_mul_f32 v252, v192, v252
    v_fma_f32 v160, v160, v248, -v252
    v_fma_f32 v192, v192, v248, v7
    v_mul_f32 v7, v161, v253
    v_mul_f32 v253, v193, v253
    v_fma_f32 v161, v161, v249, -v253
    v_fma_f32 v193, v193, v249, v7
    v_mul_f32 v7, v162, v254
    v_mul_f32 v254, v194, v254
    v_fma_f32 v162, v162, v250, -v254
    v_fma_f32 v194, v194, v250, v7
    v_mfma_f32_32x32x16_bf16 v[168:183], v[32:35], v[200:203], v[168:183]
    v_mul_f32 v7, v163, v255
    v_mul_f32 v255, v195, v255
    v_fma_f32 v163, v163, v251, -v255
    v_fma_f32 v195, v195, v251, v7
    v_fmamk_f32 v248, v5, 0x41c00000, v6
    v_fmamk_f32 v249, v5, 0x41c80000, v6
    v_fmamk_f32 v250, v5, 0x41d00000, v6
    v_fmamk_f32 v251, v5, 0x41d80000, v6
    v_sin_f32 v252, v248
    v_sin_f32 v253, v249
    v_sin_f32 v254, v250
    v_sin_f32 v255, v251
    v_cos_f32 v248, v248
    v_cos_f32 v249, v249
    v_cos_f32 v250, v250
    v_cos_f32 v251, v251
    v_mfma_f32_32x32x16_bf16 v[136:151], v[28:31], v[220:223], v[136:151]
    v_mul_f32 v7, v164, v252
    v_mul_f32 v252, v196, v252
    v_fma_f32 v164, v164, v248, -v252
    v_fma_f32 v196, v196, v248, v7
    v_mul_f32 v7, v165, v253
    v_mul_f32 v253, v197, v253
    v_fma_f32 v165, v165, v249, -v253
    v_fma_f32 v197, v197, v249, v7
    v_mul_f32 v7, v166, v254
    v_mul_f32 v254, v198, v254
    v_fma_f32 v166, v166, v250, -v254
    v_fma_f32 v198, v198, v250, v7
    v_mul_f32 v7, v167, v255
    v_mul_f32 v255, v199, v255
    v_fma_f32 v167, v167, v251, -v255
    v_fma_f32 v199, v199, v251, v7
    v_mfma_f32_32x32x16_bf16 v[168:183], v[36:39], v[204:207], v[168:183]
    v_cvt_pk_bf16_f32 v208, v152, v153
    v_cvt_pk_bf16_f32 v209, v154, v155
    v_cvt_pk_bf16_f32 v210, v156, v157
    v_cvt_pk_bf16_f32 v211, v158, v159
    v_cvt_pk_bf16_f32 v212, v160, v161
    v_cvt_pk_bf16_f32 v213, v162, v163
    v_cvt_pk_bf16_f32 v214, v164, v165
    v_cvt_pk_bf16_f32 v215, v166, v167
    v_cvt_pk_bf16_f32 v224, v184, v185
    v_cvt_pk_bf16_f32 v225, v186, v187
    v_cvt_pk_bf16_f32 v226, v188, v189
    v_cvt_pk_bf16_f32 v227, v190, v191
    v_cvt_pk_bf16_f32 v228, v192, v193
    v_cvt_pk_bf16_f32 v229, v194, v195
    v_cvt_pk_bf16_f32 v230, v196, v197
    v_cvt_pk_bf16_f32 v231, v198, v199
    v_mfma_f32_32x32x16_bf16 v[152:167], v[16:19], v[208:211], 0
    v_mfma_f32_32x32x16_bf16 v[184:199], v[16:19], v[224:227], 0
    v_cvt_pk_bf16_f32 v104, v136, v137
    v_cvt_pk_bf16_f32 v105, v138, v139
    v_cvt_pk_bf16_f32 v108, v140, v141
    v_cvt_pk_bf16_f32 v109, v142, v143
    v_mfma_f32_32x32x16_bf16 v[152:167], v[20:23], v[212:215], v[152:167]
    v_cvt_pk_bf16_f32 v106, v144, v145
    v_cvt_pk_bf16_f32 v107, v146, v147
    v_cvt_pk_bf16_f32 v110, v148, v149
    v_cvt_pk_bf16_f32 v111, v150, v151
    v_mfma_f32_32x32x16_bf16 v[184:199], v[20:23], v[228:231], v[184:199]
    v_permlane32_swap_b32 v104, v106
    v_permlane32_swap_b32 v105, v107
    v_permlane32_swap_b32 v108, v110
    v_permlane32_swap_b32 v109, v111
    v_mfma_f32_32x32x16_bf16 v[152:167], v[24:27], v[224:227], v[152:167]
    buffer_store_dwordx4 v[104:107], v2, s[20:23], s77 offen offset:0 sc0 sc1
    buffer_store_dwordx4 v[108:111], v2, s[20:23], s77 offen offset:16 sc0 sc1
    v_cvt_pk_bf16_f32 v112, v168, v169
    v_cvt_pk_bf16_f32 v113, v170, v171
    v_mfma_f32_32x32x16_bf16 v[184:199], v[32:35], v[208:211], v[184:199]
    v_cvt_pk_bf16_f32 v116, v172, v173
    v_cvt_pk_bf16_f32 v117, v174, v175
    v_cvt_pk_bf16_f32 v114, v176, v177
    v_cvt_pk_bf16_f32 v115, v178, v179
    v_mfma_f32_32x32x16_bf16 v[152:167], v[28:31], v[228:231], v[152:167]
    v_cvt_pk_bf16_f32 v118, v180, v181
    v_cvt_pk_bf16_f32 v119, v182, v183
    v_permlane32_swap_b32 v112, v114
    v_permlane32_swap_b32 v113, v115
    v_mfma_f32_32x32x16_bf16 v[184:199], v[36:39], v[212:215], v[184:199]
    v_permlane32_swap_b32 v116, v118
    v_permlane32_swap_b32 v117, v119
    buffer_store_dwordx4 v[112:115], v2, s[20:23], s79 offen offset:0 sc0 sc1
    buffer_store_dwordx4 v[116:119], v2, s[20:23], s79 offen offset:16 sc0 sc1
    s_nop 2
    v_cvt_pk_bf16_f32 v120, v152, v153
    v_cvt_pk_bf16_f32 v121, v154, v155
    v_cvt_pk_bf16_f32 v124, v156, v157
    v_cvt_pk_bf16_f32 v125, v158, v159
    v_cvt_pk_bf16_f32 v122, v160, v161
    v_cvt_pk_bf16_f32 v123, v162, v163
    v_cvt_pk_bf16_f32 v126, v164, v165
    v_cvt_pk_bf16_f32 v127, v166, v167
    v_permlane32_swap_b32 v120, v122
    v_permlane32_swap_b32 v121, v123
    v_permlane32_swap_b32 v124, v126
    v_permlane32_swap_b32 v125, v127
    buffer_store_dwordx4 v[120:123], v2, s[20:23], s77 offen offset:2048 sc0 sc1
    buffer_store_dwordx4 v[124:127], v2, s[20:23], s77 offen offset:2064 sc0 sc1
    v_cvt_pk_bf16_f32 v128, v184, v185
    v_cvt_pk_bf16_f32 v129, v186, v187
    v_cvt_pk_bf16_f32 v132, v188, v189
    v_cvt_pk_bf16_f32 v133, v190, v191
    v_cvt_pk_bf16_f32 v130, v192, v193
    v_cvt_pk_bf16_f32 v131, v194, v195
    v_cvt_pk_bf16_f32 v134, v196, v197
    v_cvt_pk_bf16_f32 v135, v198, v199
    v_permlane32_swap_b32 v128, v130
    v_permlane32_swap_b32 v129, v131
    v_permlane32_swap_b32 v132, v134
    v_permlane32_swap_b32 v133, v135
    buffer_store_dwordx4 v[128:131], v2, s[20:23], s79 offen offset:2048 sc0 sc1
    buffer_store_dwordx4 v[132:135], v2, s[20:23], s79 offen offset:2064 sc0 sc1
K2_FFT_SKIP:
    v_mov_b32 v80, v8
    v_mov_b32 v81, v9
    s_lshl_b32 s77, s2, 6
    s_add_u32 s77, s77, 0xb85800
    v_mov_b32 v8, s77
    v_mov_b32 v9, 1
    s_waitcnt vmcnt(0)
    s_mov_b64 exec, 1
    buffer_store_dword v9, v8, s[20:23], 0 offen sc0 sc1
    s_mov_b64 exec, -1
    s_setprio 0
    s_cmp_ge_u32 s2, 224
    s_cbranch_scc1 K2_END
    v_sub_f32 v92, 1.0, v80
    v_sub_f32 v93, 1.0, v81
    v_mul_f32 v80, 0x36124925, v80
    v_mul_f32 v81, 0x36124925, v81
    v_lshlrev_b32 v7, 4, v1
    v_and_b32 v12, 31, v1
    v_lshrrev_b32 v13, 5, v1
    s_lshl_b32 s80, s75, 6
    v_add_u32 v208, s80, v12
    v_cvt_f32_u32 v208, v208
    v_mul_f32 v208, 0x3b124925, v208
    v_add_f32 v209, 0x3d924925, v208
    s_and_b32 s80, s36, 3
    s_lshl_b32 s80, s80, 6
    v_lshlrev_b32 v210, 3, v13
    v_add_u32 v210, s80, v210
    v_cvt_f32_u32 v210, v210
    s_cmp_ge_u32 s36, 4
    s_cselect_b32 s81, 0x3e800000, 0
    s_cselect_b32 s82, 0, 0.5
    v_mov_b32 v211, s81
    v_mov_b32 v212, s82
    v_fma_f32 v213, v210, v208, v211
    v_fma_f32 v214, v210, v209, v211
    v_cos_f32 v215, v208
    v_cos_f32 v216, v209
    v_add_f32 v215, v215, v215
    v_add_f32 v216, v216, v216
    v_mov_b32 v217, 0x43600000
    v_mov_b32 v218, 0
    v_mov_b32 v219, 1.0
    v_add_f32 v236, 0x00000000, v210
    v_cmp_lt_f32 vcc, v217, v236
    s_nop 1
    v_cndmask_b32 v228, v219, v218, vcc
    v_cmp_eq_f32 vcc, v217, v236
    s_nop 1
    v_cndmask_b32 v228, v228, v212, vcc
    v_cmp_eq_f32 vcc, 0, v236
    s_nop 1
    v_cndmask_b32 v228, v228, v212, vcc
    v_fmamk_f32 v220, v208, 0x00000000, v213
    v_fmamk_f32 v221, v208, 0x3f800000, v213
    v_cos_f32 v220, v220
    v_cos_f32 v221, v221
    s_nop 0
    v_fma_f32 v222, v215, v221, -v220
    v_fma_f32 v223, v215, v222, -v221
    v_fma_f32 v224, v215, v223, -v222
    v_fma_f32 v225, v215, v224, -v223
    v_fma_f32 v226, v215, v225, -v224
    v_fma_f32 v227, v215, v226, -v225
    v_mul_f32 v220, v220, v228
    v_cvt_pk_bf16_f32 v96, v220, v221
    v_cvt_pk_bf16_f32 v97, v222, v223
    v_cvt_pk_bf16_f32 v98, v224, v225
    v_cvt_pk_bf16_f32 v99, v226, v227
    v_fmamk_f32 v220, v209, 0x00000000, v214
    v_fmamk_f32 v221, v209, 0x3f800000, v214
    v_cos_f32 v220, v220
    v_cos_f32 v221, v221
    s_nop 0
    v_fma_f32 v222, v216, v221, -v220
    v_fma_f32 v223, v216, v222, -v221
    v_fma_f32 v224, v216, v223, -v222
    v_fma_f32 v225, v216, v224, -v223
    v_fma_f32 v226, v216, v225, -v224
    v_fma_f32 v227, v216, v226, -v225
    v_mul_f32 v220, v220, v228
    v_cvt_pk_bf16_f32 v112, v220, v221
    v_cvt_pk_bf16_f32 v113, v222, v223
    v_cvt_pk_bf16_f32 v114, v224, v225
    v_cvt_pk_bf16_f32 v115, v226, v227
    v_fmamk_f32 v220, v208, 0x41800000, v213
    v_fmamk_f32 v221, v208, 0x41880000, v213
    v_cos_f32 v220, v220
    v_cos_f32 v221, v221
    s_nop 0
    v_fma_f32 v222, v215, v221, -v220
    v_fma_f32 v223, v215, v222, -v221
    v_fma_f32 v224, v215, v223, -v222
    v_fma_f32 v225, v215, v224, -v223
    v_fma_f32 v226, v215, v225, -v224
    v_fma_f32 v227, v215, v226, -v225
    v_cvt_pk_bf16_f32 v100, v220, v221
    v_cvt_pk_bf16_f32 v101, v222, v223
    v_cvt_pk_bf16_f32 v102, v224, v225
    v_cvt_pk_bf16_f32 v103, v226, v227
    v_fmamk_f32 v220, v209, 0x41800000, v214
    v_fmamk_f32 v221, v209, 0x41880000, v214
    v_cos_f32 v220, v220
    v_cos_f32 v221, v221
    s_nop 0
    v_fma_f32 v222, v216, v221, -v220
    v_fma_f32 v223, v216, v222, -v221
    v_fma_f32 v224, v216, v223, -v222
    v_fma_f32 v225, v216, v224, -v223
    v_fma_f32 v226, v216, v225, -v224
    v_fma_f32 v227, v216, v226, -v225
    v_cvt_pk_bf16_f32 v116, v220, v221
    v_cvt_pk_bf16_f32 v117, v222, v223
    v_cvt_pk_bf16_f32 v118, v224, v225
    v_cvt_pk_bf16_f32 v119, v226, v227
    v_add_f32 v236, 0x42000000, v210
    v_cmp_lt_f32 vcc, v217, v236
    s_nop 1
    v_cndmask_b32 v228, v219, v218, vcc
    v_cmp_eq_f32 vcc, v217, v236
    s_nop 1
    v_cndmask_b32 v228, v228, v212, vcc
    v_cmp_eq_f32 vcc, 0, v236
    s_nop 1
    v_cndmask_b32 v228, v228, v212, vcc
    v_add_f32 v236, 0x42040000, v210
    v_cmp_lt_f32 vcc, v217, v236
    s_nop 1
    v_cndmask_b32 v229, v219, v218, vcc
    v_cmp_eq_f32 vcc, v217, v236
    s_nop 1
    v_cndmask_b32 v229, v229, v212, vcc
    v_cmp_eq_f32 vcc, 0, v236
    s_nop 1
    v_cndmask_b32 v229, v229, v212, vcc
    v_add_f32 v236, 0x42080000, v210
    v_cmp_lt_f32 vcc, v217, v236
    s_nop 1
    v_cndmask_b32 v230, v219, v218, vcc
    v_cmp_eq_f32 vcc, v217, v236
    s_nop 1
    v_cndmask_b32 v230, v230, v212, vcc
    v_cmp_eq_f32 vcc, 0, v236
    s_nop 1
    v_cndmask_b32 v230, v230, v212, vcc
    v_add_f32 v236, 0x420c0000, v210
    v_cmp_lt_f32 vcc, v217, v236
    s_nop 1
    v_cndmask_b32 v231, v219, v218, vcc
    v_cmp_eq_f32 vcc, v217, v236
    s_nop 1
    v_cndmask_b32 v231, v231, v212, vcc
    v_cmp_eq_f32 vcc, 0, v236
    s_nop 1
    v_cndmask_b32 v231, v231, v212, vcc
    v_add_f32 v236, 0x42100000, v210
    v_cmp_lt_f32 vcc, v217, v236
    s_nop 1
    v_cndmask_b32 v232, v219, v218, vcc
    v_cmp_eq_f32 vcc, v217, v236
    s_nop 1
    v_cndmask_b32 v232, v232, v212, vcc
    v_cmp_eq_f32 vcc, 0, v236
    s_nop 1
    v_cndmask_b32 v232, v232, v212, vcc
    v_add_f32 v236, 0x42140000, v210
    v_cmp_lt_f32 vcc, v217, v236
    s_nop 1
    v_cndmask_b32 v233, v219, v218, vcc
    v_cmp_eq_f32 vcc, v217, v236
    s_nop 1
    v_cndmask_b32 v233, v233, v212, vcc
    v_cmp_eq_f32 vcc, 0, v236
    s_nop 1
    v_cndmask_b32 v233, v233, v212, vcc
    v_add_f32 v236, 0x42180000, v210
    v_cmp_lt_f32 vcc, v217, v236
    s_nop 1
    v_cndmask_b32 v234, v219, v218, vcc
    v_cmp_eq_f32 vcc, v217, v236
    s_nop 1
    v_cndmask_b32 v234, v234, v212, vcc
    v_cmp_eq_f32 vcc, 0, v236
    s_nop 1
    v_cndmask_b32 v234, v234, v212, vcc
    v_add_f32 v236, 0x421c0000, v210
    v_cmp_lt_f32 vcc, v217, v236
    s_nop 1
    v_cndmask_b32 v235, v219, v218, vcc
    v_cmp_eq_f32 vcc, v217, v236
    s_nop 1
    v_cndmask_b32 v235, v235, v212, vcc
    v_cmp_eq_f32 vcc, 0, v236
    s_nop 1
    v_cndmask_b32 v235, v235, v212, vcc
    v_fmamk_f32 v220, v208, 0x42000000, v213
    v_fmamk_f32 v221, v208, 0x42040000, v213
    v_cos_f32 v220, v220
    v_cos_f32 v221, v221
    s_nop 0
    v_fma_f32 v222, v215, v221, -v220
    v_fma_f32 v223, v215, v222, -v221
    v_fma_f32 v224, v215, v223, -v222
    v_fma_f32 v225, v215, v224, -v223
    v_fma_f32 v226, v215, v225, -v224
    v_fma_f32 v227, v215, v226, -v225
    v_mul_f32 v220, v220, v228
    v_mul_f32 v221, v221, v229
    v_mul_f32 v222, v222, v230
    v_mul_f32 v223, v223, v231
    v_mul_f32 v224, v224, v232
    v_mul_f32 v225, v225, v233
    v_mul_f32 v226, v226, v234
    v_mul_f32 v227, v227, v235
    v_cvt_pk_bf16_f32 v104, v220, v221
    v_cvt_pk_bf16_f32 v105, v222, v223
    v_cvt_pk_bf16_f32 v106, v224, v225
    v_cvt_pk_bf16_f32 v107, v226, v227
    v_fmamk_f32 v220, v209, 0x42000000, v214
    v_fmamk_f32 v221, v209, 0x42040000, v214
    v_cos_f32 v220, v220
    v_cos_f32 v221, v221
    s_nop 0
    v_fma_f32 v222, v216, v221, -v220
    v_fma_f32 v223, v216, v222, -v221
    v_fma_f32 v224, v216, v223, -v222
    v_fma_f32 v225, v216, v224, -v223
    v_fma_f32 v226, v216, v225, -v224
    v_fma_f32 v227, v216, v226, -v225
    v_mul_f32 v220, v220, v228
    v_mul_f32 v221, v221, v229
    v_mul_f32 v222, v222, v230
    v_mul_f32 v223, v223, v231
    v_mul_f32 v224, v224, v232
    v_mul_f32 v225, v225, v233
    v_mul_f32 v226, v226, v234
    v_mul_f32 v227, v227, v235
    v_cvt_pk_bf16_f32 v120, v220, v221
    v_cvt_pk_bf16_f32 v121, v222, v223
    v_cvt_pk_bf16_f32 v122, v224, v225
    v_cvt_pk_bf16_f32 v123, v226, v227
    v_add_f32 v236, 0x42400000, v210
    v_cmp_lt_f32 vcc, v217, v236
    s_nop 1
    v_cndmask_b32 v228, v219, v218, vcc
    v_cmp_eq_f32 vcc, v217, v236
    s_nop 1
    v_cndmask_b32 v228, v228, v212, vcc
    v_cmp_eq_f32 vcc, 0, v236
    s_nop 1
    v_cndmask_b32 v228, v228, v212, vcc
    v_add_f32 v236, 0x42440000, v210
    v_cmp_lt_f32 vcc, v217, v236
    s_nop 1
    v_cndmask_b32 v229, v219, v218, vcc
    v_cmp_eq_f32 vcc, v217, v236
    s_nop 1
    v_cndmask_b32 v229, v229, v212, vcc
    v_cmp_eq_f32 vcc, 0, v236
    s_nop 1
    v_cndmask_b32 v229, v229, v212, vcc
    v_add_f32 v236, 0x42480000, v210
    v_cmp_lt_f32 vcc, v217, v236
    s_nop 1
    v_cndmask_b32 v230, v219, v218, vcc
    v_cmp_eq_f32 vcc, v217, v236
    s_nop 1
    v_cndmask_b32 v230, v230, v212, vcc
    v_cmp_eq_f32 vcc, 0, v236
    s_nop 1
    v_cndmask_b32 v230, v230, v212, vcc
    v_add_f32 v236, 0x424c0000, v210
    v_cmp_lt_f32 vcc, v217, v236
    s_nop 1
    v_cndmask_b32 v231, v219, v218, vcc
    v_cmp_eq_f32 vcc, v217, v236
    s_nop 1
    v_cndmask_b32 v231, v231, v212, vcc
    v_cmp_eq_f32 vcc, 0, v236
    s_nop 1
    v_cndmask_b32 v231, v231, v212, vcc
    v_add_f32 v236, 0x42500000, v210
    v_cmp_lt_f32 vcc, v217, v236
    s_nop 1
    v_cndmask_b32 v232, v219, v218, vcc
    v_cmp_eq_f32 vcc, v217, v236
    s_nop 1
    v_cndmask_b32 v232, v232, v212, vcc
    v_cmp_eq_f32 vcc, 0, v236
    s_nop 1
    v_cndmask_b32 v232, v232, v212, vcc
    v_add_f32 v236, 0x42540000, v210
    v_cmp_lt_f32 vcc, v217, v236
    s_nop 1
    v_cndmask_b32 v233, v219, v218, vcc
    v_cmp_eq_f32 vcc, v217, v236
    s_nop 1
    v_cndmask_b32 v233, v233, v212, vcc
    v_cmp_eq_f32 vcc, 0, v236
    s_nop 1
    v_cndmask_b32 v233, v233, v212, vcc
    v_add_f32 v236, 0x42580000, v210
    v_cmp_lt_f32 vcc, v217, v236
    s_nop 1
    v_cndmask_b32 v234, v219, v218, vcc
    v_cmp_eq_f32 vcc, v217, v236
    s_nop 1
    v_cndmask_b32 v234, v234, v212, vcc
    v_cmp_eq_f32 vcc, 0, v236
    s_nop 1
    v_cndmask_b32 v234, v234, v212, vcc
    v_add_f32 v236, 0x425c0000, v210
    v_cmp_lt_f32 vcc, v217, v236
    s_nop 1
    v_cndmask_b32 v235, v219, v218, vcc
    v_cmp_eq_f32 vcc, v217, v236
    s_nop 1
    v_cndmask_b32 v235, v235, v212, vcc
    v_cmp_eq_f32 vcc, 0, v236
    s_nop 1
    v_cndmask_b32 v235, v235, v212, vcc
    v_fmamk_f32 v220, v208, 0x42400000, v213
    v_fmamk_f32 v221, v208, 0x42440000, v213
    v_cos_f32 v220, v220
    v_cos_f32 v221, v221
    s_nop 0
    v_fma_f32 v222, v215, v221, -v220
    v_fma_f32 v223, v215, v222, -v221
    v_fma_f32 v224, v215, v223, -v222
    v_fma_f32 v225, v215, v224, -v223
    v_fma_f32 v226, v215, v225, -v224
    v_fma_f32 v227, v215, v226, -v225
    v_mul_f32 v220, v220, v228
    v_mul_f32 v221, v221, v229
    v_mul_f32 v222, v222, v230
    v_mul_f32 v223, v223, v231
    v_mul_f32 v224, v224, v232
    v_mul_f32 v225, v225, v233
    v_mul_f32 v226, v226, v234
    v_mul_f32 v227, v227, v235
    v_cvt_pk_bf16_f32 v108, v220, v221
    v_cvt_pk_bf16_f32 v109, v222, v223
    v_cvt_pk_bf16_f32 v110, v224, v225
    v_cvt_pk_bf16_f32 v111, v226, v227
    v_fmamk_f32 v220, v209, 0x42400000, v214
    v_fmamk_f32 v221, v209, 0x42440000, v214
    v_cos_f32 v220, v220
    v_cos_f32 v221, v221
    s_nop 0
    v_fma_f32 v222, v216, v221, -v220
    v_fma_f32 v223, v216, v222, -v221
    v_fma_f32 v224, v216, v223, -v222
    v_fma_f32 v225, v216, v224, -v223
    v_fma_f32 v226, v216, v225, -v224
    v_fma_f32 v227, v216, v226, -v225
    v_mul_f32 v220, v220, v228
    v_mul_f32 v221, v221, v229
    v_mul_f32 v222, v222, v230
    v_mul_f32 v223, v223, v231
    v_mul_f32 v224, v224, v232
    v_mul_f32 v225, v225, v233
    v_mul_f32 v226, v226, v234
    v_mul_f32 v227, v227, v235
    v_cvt_pk_bf16_f32 v124, v220, v221
    v_cvt_pk_bf16_f32 v125, v222, v223
    v_cvt_pk_bf16_f32 v126, v224, v225
    v_cvt_pk_bf16_f32 v127, v226, v227
    s_and_b32 s83, s36, 3
    s_lshl_b32 s83, s83, 6
    v_lshrrev_b32 v8, 3, v1
    v_add_u32 v8, s83, v8
    v_lshrrev_b32 v10, 4, v1
    v_and_b32 v10, 1, v10
    v_lshlrev_b32 v10, 2, v10
    v_and_b32 v11, 7, v1
    v_xor_b32 v10, v11, v10
    v_lshlrev_b32 v10, 4, v10
    s_lshr_b32 s84, s36, 2
    s_mul_i32 s84, s84, 921600
    s_lshl_b32 s85, s74, 7
    s_add_u32 s84, s84, s85
    s_add_u32 s84, s84, 0xc00000
    v_mov_b32 v15, 224
    s_mov_b32 s85, 0xb85800
    v_add_u32 v9, 0, v8
    v_min_u32 v9, v9, v15
    v_lshl_add_u32 v82, v9, 12, v10
    v_add_u32 v9, 8, v8
    v_min_u32 v9, v9, v15
    v_lshl_add_u32 v83, v9, 12, v10
    v_add_u32 v9, 16, v8
    v_min_u32 v9, v9, v15
    v_lshl_add_u32 v84, v9, 12, v10
    v_add_u32 v9, 24, v8
    v_min_u32 v9, v9, v15
    v_lshl_add_u32 v85, v9, 12, v10
    v_add_u32 v9, 32, v8
    v_min_u32 v9, v9, v15
    v_lshl_add_u32 v86, v9, 12, v10
    v_add_u32 v9, 40, v8
    v_min_u32 v9, v9, v15
    v_lshl_add_u32 v87, v9, 12, v10
    v_add_u32 v9, 48, v8
    v_min_u32 v9, v9, v15
    v_lshl_add_u32 v88, v9, 12, v10
    v_add_u32 v9, 56, v8
    v_min_u32 v9, v9, v15
    v_lshl_add_u32 v89, v9, 12, v10
    v_and_b32 v8, 15, v1
    v_lshrrev_b32 v9, 2, v8
    v_lshrrev_b32 v10, 5, v1
    v_lshl_add_u32 v9, v10, 3, v9
    v_lshlrev_b32 v9, 7, v9
    v_lshrrev_b32 v10, 4, v1
    v_and_b32 v10, 1, v10
    v_lshlrev_b32 v10, 1, v10
    v_lshrrev_b32 v11, 1, v8
    v_and_b32 v11, 1, v11
    v_add_u32 v10, v10, v11
    v_add_u32 v10, 0, v10
    v_lshrrev_b32 v11, 3, v8
    v_lshlrev_b32 v11, 2, v11
    v_xor_b32 v10, v10, v11
    v_lshl_add_u32 v9, v10, 4, v9
    v_and_b32 v11, 1, v8
    v_lshl_add_u32 v90, v11, 3, v9
    v_add_u32 v90, s78, v90
    v_xor_b32 v91, 64, v90
    v_mov_b32 v144, 0
    v_mov_b32 v145, 0
    v_mov_b32 v146, 0
    v_mov_b32 v147, 0
    v_mov_b32 v148, 0
    v_mov_b32 v149, 0
    v_mov_b32 v150, 0
    v_mov_b32 v151, 0
    v_mov_b32 v152, 0
    v_mov_b32 v153, 0
    v_mov_b32 v154, 0
    v_mov_b32 v155, 0
    v_mov_b32 v156, 0
    v_mov_b32 v157, 0
    v_mov_b32 v158, 0
    v_mov_b32 v159, 0
    v_mov_b32 v160, 0
    v_mov_b32 v161, 0
    v_mov_b32 v162, 0
    v_mov_b32 v163, 0
    v_mov_b32 v164, 0
    v_mov_b32 v165, 0
    v_mov_b32 v166, 0
    v_mov_b32 v167, 0
    v_mov_b32 v168, 0
    v_mov_b32 v169, 0
    v_mov_b32 v170, 0
    v_mov_b32 v171, 0
    v_mov_b32 v172, 0
    v_mov_b32 v173, 0
    v_mov_b32 v174, 0
    v_mov_b32 v175, 0
    v_mov_b32 v176, 0
    v_mov_b32 v177, 0
    v_mov_b32 v178, 0
    v_mov_b32 v179, 0
    v_mov_b32 v180, 0
    v_mov_b32 v181, 0
    v_mov_b32 v182, 0
    v_mov_b32 v183, 0
    v_mov_b32 v184, 0
    v_mov_b32 v185, 0
    v_mov_b32 v186, 0
    v_mov_b32 v187, 0
    v_mov_b32 v188, 0
    v_mov_b32 v189, 0
    v_mov_b32 v190, 0
    v_mov_b32 v191, 0
    v_mov_b32 v192, 0
    v_mov_b32 v193, 0
    v_mov_b32 v194, 0
    v_mov_b32 v195, 0
    v_mov_b32 v196, 0
    v_mov_b32 v197, 0
    v_mov_b32 v198, 0
    v_mov_b32 v199, 0
    v_mov_b32 v200, 0
    v_mov_b32 v201, 0
    v_mov_b32 v202, 0
    v_mov_b32 v203, 0
    v_mov_b32 v204, 0
    v_mov_b32 v205, 0
    v_mov_b32 v206, 0
    v_mov_b32 v207, 0
    s_branch K2_TAIL
K2_END:
    s_endpgm
.section .rodata,"a"
.p2align 6
.amdhsa_kernel k1_gateup_dft_kernel
  .amdhsa_next_free_vgpr 224
  .amdhsa_next_free_sgpr 102
  .amdhsa_accum_offset 224
  .amdhsa_group_segment_fixed_size 0
  .amdhsa_kernarg_size 88
  .amdhsa_user_sgpr_count 2
  .amdhsa_user_sgpr_kernarg_segment_ptr 1
  .amdhsa_system_sgpr_workgroup_id_x 1
.end_amdhsa_kernel
.p2align 6
.amdhsa_kernel k2_down_fft_kernel
  .amdhsa_next_free_vgpr 256
  .amdhsa_next_free_sgpr 102
  .amdhsa_accum_offset 256
  .amdhsa_group_segment_fixed_size 0
  .amdhsa_kernarg_size 88
  .amdhsa_user_sgpr_count 2
  .amdhsa_user_sgpr_kernarg_segment_ptr 1
  .amdhsa_system_sgpr_workgroup_id_x 1
.end_amdhsa_kernel
```
